```python
import torch

def _softmax(x, axis=-1):
    return torch.softmax(x, dim=axis)
def _gelu(x):
    return torch.nn.functional.gelu(x, approximate="tanh")
def _silu(x):
    return torch.nn.functional.silu(x)
def _sigmoid(x):
    return torch.sigmoid(x)
def _layernorm(x, axis=-1, eps=1e-5):
    m = x.mean(dim=axis, keepdim=True)
    v = x.var(dim=axis, keepdim=True, unbiased=False)
    return (x - m) / torch.sqrt(v + eps)
def _scatter_add(tgt, idx, src, axis=0):
    return tgt.clone().index_add_(axis, idx, src)
def _segment_sum(src, seg, n):
    out = torch.zeros((n,) + src.shape[1:], dtype=src.dtype)
    return out.index_add_(0, seg, src)
def _pad(x, pw):
    flat = tuple(v for pair in reversed(pw) for v in pair)
    return torch.nn.functional.pad(x, flat)

kernel_name = 'sequential_preLN__ssm_conv_h3__geglu_ffn__prompt'

def setup_inputs():

    _w = (lambda a: (lambda t: t.to(torch.bfloat16) if t.is_floating_point() else t)(torch.as_tensor(a)))
    def _A_setup():
        B, S, D = 1, 2048, 512
        ks = 4
        return {
            "q": _w((lambda *s: torch.randn(*s, dtype=torch.bfloat16) * 0.05)(B, S, D)),
            "k": _w((lambda *s: torch.randn(*s, dtype=torch.bfloat16) * 0.4)(B, S, D)),
            "v": _w((lambda *s: torch.randn(*s, dtype=torch.bfloat16) * 0.4)(B, S, D)),
            "shift_k": _w((lambda *s: torch.randn(*s, dtype=torch.bfloat16) * 0.4)(D, ks) * 0.5),
            "ssm_k": _w((lambda *s: torch.randn(*s, dtype=torch.bfloat16) * 0.4)(D, S) * (1.0 / S ** 0.5)),
            "ssm_D": _w((lambda *s: torch.randn(*s, dtype=torch.bfloat16) * 0.4)(D)),
        }
    _A_in = _A_setup()

    def _B_setup():
        B, S, D, F = 1, 2048, 512, 1792
        return {
            "x": _w((lambda *s: torch.randn(*s, dtype=torch.bfloat16) * 0.05)(B, S, D)),
            "w_gate": _w((lambda *s: torch.randn(*s, dtype=torch.bfloat16) * 0.05)(D, F)),
            "w_up": _w((lambda *s: torch.randn(*s, dtype=torch.bfloat16) * 0.05)(D, F)),
            "w_down": _w((lambda *s: torch.randn(*s, dtype=torch.bfloat16) * 0.05)(F, D)),
        }
    _B_in = _B_setup()

    return {
        "A_q": _A_in["q"],
        "A_k": _A_in["k"],
        "A_v": _A_in["v"],
        "A_shift_k": _A_in["shift_k"],
        "A_ssm_k": _A_in["ssm_k"],
        "A_ssm_D": _A_in["ssm_D"],
        "B_x": _B_in["x"],
        "B_w_gate": _B_in["w_gate"],
        "B_w_up": _B_in["w_up"],
        "B_w_down": _B_in["w_down"],
    }

def reference(A_q, A_k, A_v, A_shift_k, A_ssm_k, A_ssm_D, B_x, B_w_gate, B_w_up, B_w_down):
    def _A_ref(q, k, v, shift_k, ssm_k, ssm_D):
        B, S, D = q.shape
        ks = shift_k.shape[-1]
        k_pad = _pad(k, ((0, 0), (ks - 1, 0), (0, 0)))
        k_shift = torch.zeros_like(k)
        for t in range(ks):
            k_shift = k_shift + k_pad[:, t:t + S, :] * shift_k[:, ks - 1 - t][None, None, :]
        kv = k_shift * v
        L = 2 * S
        kv_pad = _pad(kv, ((0, 0), (0, S), (0, 0)))
        kf_pad = _pad(ssm_k, ((0, 0), (0, S)))
        kv_f = (lambda x, axes=(-2,-1): torch.fft.rfft2(x.float(), dim=axes))(kv_pad[:, None, :, :], axes=(1, 2))
        kf_f = (lambda x, axes=(-2,-1): torch.fft.rfft2(x.float(), dim=axes))(kf_pad[:, None, :], axes=(1, 2))
        kf_f = (lambda x, *d: x.permute(*d))(kf_f, 1, 2, 0)
        y_f = kv_f * kf_f[None, :, :, :]
        y = (lambda x, s, axes=(-2,-1): torch.fft.irfft2(x, s=s, dim=axes).to(torch.bfloat16))(y_f, (1, L), axes=(1, 2))[:, 0, :S, :]
        y = y + kv * ssm_D[None, None, :]
        return q * y

    def _B_ref(x, w_gate, w_up, w_down):
        return (_gelu(x @ w_gate) * (x @ w_up)) @ w_down

    x = A_q
    h = x + _A_ref(_layernorm(x, axis=-1), A_k, A_v, A_shift_k, A_ssm_k, A_ssm_D)
    h2 = h + _B_ref(_layernorm(h, axis=-1), B_w_gate, B_w_up, B_w_down)
    return h2
```

```asm
; @launch grid=(256,1,1) block=(512,1,1) lds=163840
.amdgcn_target "amdgcn-amd-amdhsa--gfx950"
.text
.globl sequential_preLN__ssm_conv_h3__geglu_ffn__prompt_kernel
.p2align 8
.type sequential_preLN__ssm_conv_h3__geglu_ffn__prompt_kernel,@function
sequential_preLN__ssm_conv_h3__geglu_ffn__prompt_kernel:
    s_cmp_ge_u32 s2, 256
    s_cbranch_scc1 L_end
    s_load_dwordx16 s[4:19], s[0:1], 0
    s_load_dwordx8 s[20:27], s[0:1], 64
    s_load_dwordx2 s[28:29], s[0:1], 96
    v_lshrrev_b32 v1, 6, v0
    s_getpc_b64 s[44:45]
L_pc:
    v_readfirstlane_b32 s88, v1
    s_mov_b32 s89, 0x40000
    s_cmp_ge_u32 s88, 4
    s_cbranch_scc1 L_nopf
    s_mov_b32 s46, L_code_end-L_pc
    s_mov_b32 s47, 0x00020000
    v_lshlrev_b32 v1, 7, v0
    buffer_load_dword v252, v1, s[44:47], 0 offen
L_nopf:
    s_waitcnt lgkmcnt(0)
    s_mov_b32 s32, s4
    s_mov_b32 s33, s5
    s_mov_b32 s34, 2097152
    s_mov_b32 s35, 0x00020000
    s_mov_b32 s36, s6
    s_mov_b32 s37, s7
    s_mov_b32 s38, 2097152
    s_mov_b32 s39, 0x00020000
    s_mov_b32 s40, s8
    s_mov_b32 s41, s9
    s_mov_b32 s42, 2097152
    s_mov_b32 s43, 0x00020000
    s_and_b32 s52, s2, 7
    s_lshr_b32 s54, s2, 6
    s_lshl_b32 s52, s52, 2
    s_add_u32 s52, s52, s54
    s_bfe_u32 s53, s2, 0x30003
    v_and_b32 v2, 63, v0
    v_lshrrev_b32 v3, 3, v0
    v_and_b32 v1, 7, v0
    v_xor_b32 v5, s88, v1
    v_lshlrev_b32 v5, 4, v5
    v_lshl_add_u32 v5, v3, 10, v5
    s_lshl_b32 s54, s52, 16
    s_lshl_b32 s55, s53, 7
    s_add_u32 s54, s54, s55
    s_lshl_b32 s55, s88, 10
    s_add_u32 m0, s55, 1024
    v_lshlrev_b32 v4, 4, v2
    buffer_load_dwordx4 v5, s[36:39], s54 offen lds
    s_add_u32 m0, s55, 9216
    v_bfe_u32 v7, v0, 3, 5
    buffer_load_dwordx4 v5, s[40:43], s54 offen lds
    s_add_u32 m0, s55, 17408
    s_lshl_b32 s56, s53, 5
    buffer_load_dwordx4 v5, s[32:35], s54 offen lds
    s_mov_b32 s48, s28
    s_mov_b32 s49, s29
    s_mov_b32 s50, 5242880
    s_mov_b32 s51, 0x00020000
    v_add_u32 v8, s56, v7
    s_lshl_b32 s56, s52, 3
    v_add_u32 v9, s56, v1
    v_lshlrev_b32 v10, 2, v1
    v_xor_b32 v10, v10, v7
    v_lshlrev_b32 v10, 2, v10
    v_lshl_add_u32 v10, v1, 10, v10
    s_lshl_b32 s74, s53, 5
    s_add_u32 s74, s74, s52
    s_and_b32 s101, s2, 7
    s_lshl_b32 s101, s101, 5
    s_lshr_b32 s57, s2, 3
    s_add_u32 s101, s101, s57
    s_movk_i32 s57, 0x1000
    s_mov_b32 s59, 0xffff0000
    s_add_u32 s84, s28, 7340032
    s_addc_u32 s85, s29, 0
    s_mov_b32 s86, 34816
    s_mov_b32 s87, 0x00020000
    s_load_dword s100, s[84:85], 48
    s_cmp_lt_u32 s88, 4
    s_cbranch_scc1 L_conv
    s_mov_b32 s44, s10
    s_mov_b32 s45, s11
    s_mov_b32 s46, 4096
    s_mov_b32 s47, 0x00020000
    v_and_b32 v0, 0xff, v0
    v_lshlrev_b32 v3, 4, v8
    buffer_load_dwordx4 v[32:35], v3, s[44:47], 0 offen
    s_cmp_lg_u32 s88, 7
    s_cbranch_scc1 L_nohalo_1
    s_mov_b32 m0, 0
    v_add_u32 v5, s54, v5
    v_subrev_u32 v5, 0x10000, v5
    buffer_load_dwordx4 v5, s[36:39], 0 offen lds
L_nohalo_1:
    v_add_u32 v11, 7, v1
    v_and_b32 v11, 7, v11
    v_lshlrev_b32 v11, 2, v11
    v_xor_b32 v11, v11, v7
    v_lshlrev_b32 v11, 2, v11
    v_lshl_add_u32 v11, v1, 10, v11
    v_add_u32 v3, 9216, v10
    v_add_u32 v10, 1024, v10
    v_bfe_u32 v6, v9, 4, 1
    v_xor_b32 v6, v6, v9
    v_lshlrev_b32 v6, 4, v6
    v_lshl_add_u32 v6, v8, 13, v6
    s_waitcnt vmcnt(0) lgkmcnt(0)
    s_add_u32 s100, s100, 1
    s_barrier
    ds_read2_b32 v[12:13], v11 offset0:128 offset1:160
    ds_read2_b32 v[14:15], v11 offset0:192 offset1:224
    ds_read2_b32 v[16:17], v10 offset0:0 offset1:32
    ds_read2_b32 v[24:25], v3 offset0:0 offset1:32
    ds_read2_b32 v[18:19], v10 offset0:64 offset1:96
    ds_read2_b32 v[26:27], v3 offset0:64 offset1:96
    ds_read2_b32 v[20:21], v10 offset0:128 offset1:160
    ds_read2_b32 v[28:29], v3 offset0:128 offset1:160
    ds_read2_b32 v[22:23], v10 offset0:192 offset1:224
    ds_read2_b32 v[30:31], v3 offset0:192 offset1:224
    v_lshlrev_b32 v48, 16, v32
    v_lshlrev_b32 v49, 16, v34
    v_and_b32 v50, s59, v32
    v_and_b32 v51, s59, v34
    v_lshlrev_b32 v52, 16, v33
    v_lshlrev_b32 v53, 16, v35
    v_and_b32 v54, s59, v33
    v_and_b32 v55, s59, v35
    s_waitcnt lgkmcnt(8)
    v_lshlrev_b32 v56, 16, v13
    v_and_b32 v57, s59, v13
    v_lshlrev_b32 v58, 16, v14
    v_and_b32 v59, s59, v14
    v_lshlrev_b32 v60, 16, v15
    v_and_b32 v61, s59, v15
    s_waitcnt lgkmcnt(6)
    v_lshlrev_b32 v62, 16, v16
    v_and_b32 v63, s59, v16
    v_lshlrev_b32 v94, 16, v24
    v_and_b32 v95, s59, v24
    v_pk_mul_f32 v[78:79], v[56:57], v[54:55]
    v_pk_fma_f32 v[78:79], v[58:59], v[52:53], v[78:79]
    v_pk_fma_f32 v[78:79], v[60:61], v[50:51], v[78:79]
    v_pk_fma_f32 v[78:79], v[62:63], v[48:49], v[78:79]
    v_pk_mul_f32 v[78:79], v[78:79], v[94:95]
    v_lshlrev_b32 v64, 16, v17
    v_and_b32 v65, s59, v17
    v_lshlrev_b32 v94, 16, v25
    v_and_b32 v95, s59, v25
    v_pk_mul_f32 v[80:81], v[58:59], v[54:55]
    v_pk_fma_f32 v[80:81], v[60:61], v[52:53], v[80:81]
    v_pk_fma_f32 v[80:81], v[62:63], v[50:51], v[80:81]
    v_pk_fma_f32 v[80:81], v[64:65], v[48:49], v[80:81]
    v_pk_mul_f32 v[80:81], v[80:81], v[94:95]
    s_waitcnt lgkmcnt(4)
    v_lshlrev_b32 v66, 16, v18
    v_and_b32 v67, s59, v18
    v_lshlrev_b32 v94, 16, v26
    v_and_b32 v95, s59, v26
    v_pk_mul_f32 v[82:83], v[60:61], v[54:55]
    v_pk_fma_f32 v[82:83], v[62:63], v[52:53], v[82:83]
    v_pk_fma_f32 v[82:83], v[64:65], v[50:51], v[82:83]
    v_pk_fma_f32 v[82:83], v[66:67], v[48:49], v[82:83]
    v_pk_mul_f32 v[82:83], v[82:83], v[94:95]
    v_lshlrev_b32 v68, 16, v19
    v_and_b32 v69, s59, v19
    v_lshlrev_b32 v94, 16, v27
    v_and_b32 v95, s59, v27
    v_pk_mul_f32 v[84:85], v[62:63], v[54:55]
    v_pk_fma_f32 v[84:85], v[64:65], v[52:53], v[84:85]
    v_pk_fma_f32 v[84:85], v[66:67], v[50:51], v[84:85]
    v_pk_fma_f32 v[84:85], v[68:69], v[48:49], v[84:85]
    v_pk_mul_f32 v[84:85], v[84:85], v[94:95]
    s_waitcnt lgkmcnt(2)
    v_lshlrev_b32 v70, 16, v20
    v_and_b32 v71, s59, v20
    v_lshlrev_b32 v94, 16, v28
    v_and_b32 v95, s59, v28
    v_pk_mul_f32 v[86:87], v[64:65], v[54:55]
    v_pk_fma_f32 v[86:87], v[66:67], v[52:53], v[86:87]
    v_pk_fma_f32 v[86:87], v[68:69], v[50:51], v[86:87]
    v_pk_fma_f32 v[86:87], v[70:71], v[48:49], v[86:87]
    v_pk_mul_f32 v[86:87], v[86:87], v[94:95]
    v_lshlrev_b32 v72, 16, v21
    v_and_b32 v73, s59, v21
    v_lshlrev_b32 v94, 16, v29
    v_and_b32 v95, s59, v29
    v_pk_mul_f32 v[88:89], v[66:67], v[54:55]
    v_pk_fma_f32 v[88:89], v[68:69], v[52:53], v[88:89]
    v_pk_fma_f32 v[88:89], v[70:71], v[50:51], v[88:89]
    v_pk_fma_f32 v[88:89], v[72:73], v[48:49], v[88:89]
    v_pk_mul_f32 v[88:89], v[88:89], v[94:95]
    s_waitcnt lgkmcnt(0)
    v_lshlrev_b32 v74, 16, v22
    v_and_b32 v75, s59, v22
    v_lshlrev_b32 v94, 16, v30
    v_and_b32 v95, s59, v30
    v_pk_mul_f32 v[90:91], v[68:69], v[54:55]
    v_pk_fma_f32 v[90:91], v[70:71], v[52:53], v[90:91]
    v_pk_fma_f32 v[90:91], v[72:73], v[50:51], v[90:91]
    v_pk_fma_f32 v[90:91], v[74:75], v[48:49], v[90:91]
    v_pk_mul_f32 v[90:91], v[90:91], v[94:95]
    v_lshlrev_b32 v76, 16, v23
    v_and_b32 v77, s59, v23
    v_lshlrev_b32 v94, 16, v31
    v_and_b32 v95, s59, v31
    v_pk_mul_f32 v[92:93], v[70:71], v[54:55]
    v_pk_fma_f32 v[92:93], v[72:73], v[52:53], v[92:93]
    v_pk_fma_f32 v[92:93], v[74:75], v[50:51], v[92:93]
    v_pk_fma_f32 v[92:93], v[76:77], v[48:49], v[92:93]
    v_pk_mul_f32 v[92:93], v[92:93], v[94:95]
    v_cvt_pk_bf16_f32 v96, v92, v90
    v_cvt_pk_bf16_f32 v97, v88, v86
    v_cvt_pk_bf16_f32 v98, v84, v82
    v_cvt_pk_bf16_f32 v99, v80, v78
    buffer_store_dwordx4 v[96:99], v6, s[48:51], 0 offen sc1
    v_cvt_pk_bf16_f32 v100, v93, v91
    v_cvt_pk_bf16_f32 v101, v89, v87
    v_cvt_pk_bf16_f32 v102, v85, v83
    v_cvt_pk_bf16_f32 v103, v81, v79
    buffer_store_dwordx4 v[100:103], v6, s[48:51], s57 offen sc1
    s_bfe_u32 s53, s88, 0x10001
    s_and_b32 s54, s88, 1
    s_lshl_b32 s55, s101, 1
    s_add_u32 s55, s55, s53
    s_mov_b32 s32, s14
    s_mov_b32 s33, s15
    s_mov_b32 s34, 1024
    s_mov_b32 s35, 0x00020000
    s_add_u32 s36, s28, 5242880
    s_addc_u32 s37, s29, 0
    s_mov_b32 s38, 2097152
    s_mov_b32 s39, 0x00020000
    s_lshl_b32 s56, s55, 12
    s_lshl_b32 s57, s54, 11
    s_add_u32 s56, s56, s57
    s_add_u32 s56, s56, 2097152
    s_lshl_b32 s58, s57, 1
    s_add_u32 s58, s58, 4194304
    s_lshl_b32 s59, s55, 1
    v_lshlrev_b32 v5, 5, v2
    v_bfe_u32 v6, v2, 4, 1
    v_xor_b32 v6, v6, v2
    s_mul_i32 s60, s53, 4608
    s_add_u32 s60, s60, s57
    s_add_u32 s60, s60, 132608
    v_lshl_add_u32 v6, v6, 4, s60
    s_mul_i32 s90, s74, 128
    s_add_u32 s90, s90, 0
    s_lshl_b32 s91, s74, 2
    s_add_u32 s91, s91, 32768
    v_mov_b32 v250, -1
    v_writelane_b32 v250, s90, 0
    v_writelane_b32 v250, s91, 1
    s_and_b32 s90, s2, 7
    s_mul_i32 s90, s90, 4096
    v_and_b32 v243, 31, v0
    v_mul_u32_u24 v243, 128, v243
    v_add_u32 v243, s90, v243
    v_mov_b32 v244, 147456
    v_mov_b32 v251, 1
    s_mov_b64 exec, 1
    s_waitcnt vmcnt(0)
    ds_add_rtn_u32 v251, v244, v251
    s_mov_b64 exec, -1
    s_waitcnt lgkmcnt(0)
    v_readfirstlane_b32 s90, v251
    s_cmp_lg_u32 s90, 7
    s_cbranch_scc1 L_nopoll_2
    v_mov_b32 v251, s100
    buffer_store_dword v251, v250, s[84:87], 0 offen sc1
L_poll_3:
    buffer_load_dword v251, v243, s[84:87], 0 offen offset:0 sc1
    s_sub_u32 s89, s89, 1
    s_cbranch_scc1 L_pollx_4
L_polly_5:
    s_waitcnt vmcnt(0)
    v_cmp_ne_u32 vcc, s100, v251
    s_cbranch_vccnz L_poll_3
L_pollx_4:
    s_max_i32 s89, s89, 0
    s_lshl_b32 s90, s101, 13
    s_mov_b32 m0, 132608
    s_nop 0
    buffer_load_dwordx4 v4, s[48:51], s90 offen offset:0 sc1 lds
    buffer_load_dwordx4 v4, s[48:51], s90 offen offset:1024 sc1 lds
    buffer_load_dwordx4 v4, s[48:51], s90 offen offset:2048 sc1 lds
    buffer_load_dwordx4 v4, s[48:51], s90 offen offset:3072 sc1 lds
    s_add_u32 s90, s90, 4096
    s_mov_b32 m0, 137216
    s_nop 0
    buffer_load_dwordx4 v4, s[48:51], s90 offen offset:0 sc1 lds
    buffer_load_dwordx4 v4, s[48:51], s90 offen offset:1024 sc1 lds
    buffer_load_dwordx4 v4, s[48:51], s90 offen offset:2048 sc1 lds
    buffer_load_dwordx4 v4, s[48:51], s90 offen offset:3072 sc1 lds
    s_mov_b32 s91, 32768
L_poll_6:
    buffer_load_dwordx4 v[244:247], v4, s[84:87], s91 offen sc1
    s_sub_u32 s89, s89, 1
    s_cbranch_scc1 L_pollx_7
L_polly_8:
    s_waitcnt vmcnt(0)
    v_xor_b32 v244, s100, v244
    v_xor_b32 v245, s100, v245
    v_xor_b32 v246, s100, v246
    v_xor_b32 v247, s100, v247
    v_or_b32 v244, v244, v245
    v_or3_b32 v244, v244, v246, v247
    v_cmp_ne_u32 vcc, 0, v244
    s_cbranch_vccnz L_poll_6
L_pollx_7:
    s_max_i32 s89, s89, 0
    s_waitcnt vmcnt(0)
L_nopoll_2:
    s_barrier
    buffer_load_dwordx4 v[24:27], v4, s[48:51], s56 offen sc1
    buffer_load_dwordx4 v[32:35], v5, s[48:51], s58 offen sc1
    buffer_load_dwordx4 v[36:39], v5, s[48:51], s58 offen offset:16 sc1
    buffer_load_dwordx4 v[28:31], v4, s[48:51], s56 offen offset:1024 sc1
    buffer_load_dwordx4 v[40:43], v5, s[48:51], s58 offen offset:2048 sc1
    buffer_load_dwordx4 v[44:47], v5, s[48:51], s58 offen offset:2064 sc1
    buffer_load_ushort v23, off, s[32:35], s59
    ds_read_b128 v[48:51], v6
    ds_read_b128 v[52:55], v6 offset:1024
    s_and_b32 s56, s2, 7
    s_lshr_b32 s57, s2, 3
    s_and_b32 s58, s56, 3
    s_lshl_b32 s58, s58, 2
    s_and_b32 s59, s57, 3
    s_add_u32 s58, s58, s59
    s_lshr_b32 s56, s56, 2
    s_mul_i32 s56, s56, 7
    s_lshr_b32 s59, s57, 2
    s_add_u32 s59, s59, s56
    v_lshrrev_b32 v3, 4, v0
    v_bfe_u32 v13, v0, 1, 3
    v_xor_b32 v13, v13, v3
    v_and_b32 v13, 7, v13
    v_lshlrev_b32 v13, 5, v13
    v_and_b32 v15, 1, v0
    v_lshl_add_u32 v13, v15, 4, v13
    v_mul_u32_u24 v3, 3584, v3
    s_lshl_b32 s62, s59, 8
    v_add3_u32 v13, v13, v3, s62
    s_mov_b32 s64, s18
    s_mov_b32 s65, s19
    s_mov_b32 s66, 1835008
    s_mov_b32 s67, 0x00020000
    s_mov_b32 s68, s20
    s_mov_b32 s69, s21
    s_mov_b32 s70, 1835008
    s_mov_b32 s71, 0x00020000
    s_cmp_lt_u32 s57, 28
    s_cselect_b32 s66, s66, 0
    s_cselect_b32 s70, s70, 0
    s_lshl_b32 s63, s88, 10
    s_mov_b32 s62, 0
    s_add_u32 m0, s63, -4096
    s_nop 0
    buffer_load_dwordx4 v13, s[64:67], s62 offen lds
    s_add_u32 m0, s63, 45056
    s_nop 0
    buffer_load_dwordx4 v13, s[68:71], s62 offen lds
    s_add_u32 s62, s62, 57344
    s_add_u32 m0, s63, 0
    s_nop 0
    buffer_load_dwordx4 v13, s[64:67], s62 offen lds
    s_add_u32 m0, s63, 49152
    s_nop 0
    buffer_load_dwordx4 v13, s[68:71], s62 offen lds
    s_add_u32 s62, s62, 57344
    s_add_u32 m0, s63, 4096
    s_nop 0
    buffer_load_dwordx4 v13, s[64:67], s62 offen lds
    s_add_u32 m0, s63, 53248
    s_nop 0
    buffer_load_dwordx4 v13, s[68:71], s62 offen lds
    s_add_u32 s62, s62, 57344
    s_add_u32 m0, s63, 8192
    s_nop 0
    buffer_load_dwordx4 v13, s[64:67], s62 offen lds
    s_add_u32 m0, s63, 57344
    s_nop 0
    buffer_load_dwordx4 v13, s[68:71], s62 offen lds
    s_add_u32 s62, s62, 57344
    v_and_b32 v9, 1, v2
    v_bfe_u32 v10, v2, 1, 4
    v_lshlrev_b32 v10, 4, v10
    v_mul_u32_u24 v11, 640, v9
    v_xor_b32 v10, v10, v11
    v_lshrrev_b32 v11, 5, v2
    v_lshl_add_u32 v10, v11, 10, v10
    s_lshl_b32 s60, s53, 14
    s_lshl_b32 s61, s54, 12
    s_add_u32 s60, s60, s61
    s_add_u32 s60, s60, 98304
    v_add_u32 v10, s60, v10
    v_bfe_u32 v11, v2, 1, 3
    s_and_b32 s60, s55, 7
    v_xor_b32 v11, s60, v11
    v_lshlrev_b32 v11, 5, v11
    v_lshl_add_u32 v11, v9, 4, v11
    v_lshrrev_b32 v9, 4, v2
    v_lshl_add_u32 v11, v9, 17, v11
    s_lshl_b32 s72, s54, 20
    s_lshl_b32 s73, s55, 8
    s_add_u32 s72, s72, s73
    s_add_u32 s73, s72, 0x80000
    s_mov_b32 s59, 0xffff0000
    s_waitcnt vmcnt(8) lgkmcnt(0)
    v_lshlrev_b32 v23, 16, v23
    v_lshlrev_b32 v56, 16, v24
    v_and_b32 v20, s59, v32
    v_rcp_f32 v20, v20
    v_lshlrev_b32 v21, 16, v32
    v_sub_f32 v21, v56, v21
    v_mul_f32 v72, v21, v20
    v_and_b32 v21, s59, v51
    v_mul_f32 v21, v21, v23
    v_fmac_f32 v56, v72, v21
    s_add_u32 m0, s63, 12288
    s_nop 0
    buffer_load_dwordx4 v13, s[64:67], s62 offen lds
    v_and_b32 v57, s59, v24
    v_and_b32 v20, s59, v33
    v_rcp_f32 v20, v20
    v_lshlrev_b32 v21, 16, v33
    v_sub_f32 v21, v57, v21
    v_mul_f32 v73, v21, v20
    v_lshlrev_b32 v21, 16, v51
    v_mul_f32 v21, v21, v23
    v_fmac_f32 v57, v73, v21
    s_add_u32 m0, s63, 61440
    s_nop 0
    buffer_load_dwordx4 v13, s[68:71], s62 offen lds
    s_add_u32 s62, s62, 57344
    v_lshlrev_b32 v58, 16, v25
    v_and_b32 v20, s59, v34
    v_rcp_f32 v20, v20
    v_lshlrev_b32 v21, 16, v34
    v_sub_f32 v21, v58, v21
    v_mul_f32 v74, v21, v20
    v_and_b32 v21, s59, v50
    v_mul_f32 v21, v21, v23
    v_fmac_f32 v58, v74, v21
    s_add_u32 m0, s63, 16384
    s_nop 0
    buffer_load_dwordx4 v13, s[64:67], s62 offen lds
    v_and_b32 v59, s59, v25
    v_and_b32 v20, s59, v35
    v_rcp_f32 v20, v20
    v_lshlrev_b32 v21, 16, v35
    v_sub_f32 v21, v59, v21
    v_mul_f32 v75, v21, v20
    v_lshlrev_b32 v21, 16, v50
    v_mul_f32 v21, v21, v23
    v_fmac_f32 v59, v75, v21
    s_add_u32 m0, s63, 65536
    s_nop 0
    buffer_load_dwordx4 v13, s[68:71], s62 offen lds
    s_add_u32 s62, s62, 57344
    v_lshlrev_b32 v60, 16, v26
    v_and_b32 v20, s59, v36
    v_rcp_f32 v20, v20
    v_lshlrev_b32 v21, 16, v36
    v_sub_f32 v21, v60, v21
    v_mul_f32 v76, v21, v20
    v_and_b32 v21, s59, v49
    v_mul_f32 v21, v21, v23
    v_fmac_f32 v60, v76, v21
    s_add_u32 m0, s63, 20480
    s_nop 0
    buffer_load_dwordx4 v13, s[64:67], s62 offen lds
    v_and_b32 v61, s59, v26
    v_and_b32 v20, s59, v37
    v_rcp_f32 v20, v20
    v_lshlrev_b32 v21, 16, v37
    v_sub_f32 v21, v61, v21
    v_mul_f32 v77, v21, v20
    v_lshlrev_b32 v21, 16, v49
    v_mul_f32 v21, v21, v23
    v_fmac_f32 v61, v77, v21
    s_add_u32 m0, s63, 69632
    s_nop 0
    buffer_load_dwordx4 v13, s[68:71], s62 offen lds
    s_add_u32 s62, s62, 57344
    v_lshlrev_b32 v62, 16, v27
    v_and_b32 v20, s59, v38
    v_rcp_f32 v20, v20
    v_lshlrev_b32 v21, 16, v38
    v_sub_f32 v21, v62, v21
    v_mul_f32 v78, v21, v20
    v_and_b32 v21, s59, v48
    v_mul_f32 v21, v21, v23
    v_fmac_f32 v62, v78, v21
    s_add_u32 m0, s63, 24576
    s_nop 0
    buffer_load_dwordx4 v13, s[64:67], s62 offen lds
    v_and_b32 v63, s59, v27
    v_and_b32 v20, s59, v39
    v_rcp_f32 v20, v20
    v_lshlrev_b32 v21, 16, v39
    v_sub_f32 v21, v63, v21
    v_mul_f32 v79, v21, v20
    v_lshlrev_b32 v21, 16, v48
    v_mul_f32 v21, v21, v23
    v_fmac_f32 v63, v79, v21
    s_add_u32 m0, s63, 73728
    s_nop 0
    buffer_load_dwordx4 v13, s[68:71], s62 offen lds
    s_add_u32 s62, s62, 57344
    v_lshlrev_b32 v64, 16, v28
    v_and_b32 v20, s59, v40
    v_rcp_f32 v20, v20
    v_lshlrev_b32 v21, 16, v40
    v_sub_f32 v21, v64, v21
    v_mul_f32 v80, v21, v20
    v_and_b32 v21, s59, v55
    v_mul_f32 v21, v21, v23
    v_fmac_f32 v64, v80, v21
    s_add_u32 m0, s63, 28672
    s_nop 0
    buffer_load_dwordx4 v13, s[64:67], s62 offen lds
    v_and_b32 v65, s59, v28
    v_and_b32 v20, s59, v41
    v_rcp_f32 v20, v20
    v_lshlrev_b32 v21, 16, v41
    v_sub_f32 v21, v65, v21
    v_mul_f32 v81, v21, v20
    v_lshlrev_b32 v21, 16, v55
    v_mul_f32 v21, v21, v23
    v_fmac_f32 v65, v81, v21
    s_add_u32 m0, s63, 77824
    s_nop 0
    buffer_load_dwordx4 v13, s[68:71], s62 offen lds
    s_add_u32 s62, s62, 57344
    v_lshlrev_b32 v66, 16, v29
    v_and_b32 v20, s59, v42
    v_rcp_f32 v20, v20
    v_lshlrev_b32 v21, 16, v42
    v_sub_f32 v21, v66, v21
    v_mul_f32 v82, v21, v20
    v_and_b32 v21, s59, v54
    v_mul_f32 v21, v21, v23
    v_fmac_f32 v66, v82, v21
    s_add_u32 m0, s63, 32768
    s_nop 0
    buffer_load_dwordx4 v13, s[64:67], s62 offen lds
    v_and_b32 v67, s59, v29
    v_and_b32 v20, s59, v43
    v_rcp_f32 v20, v20
    v_lshlrev_b32 v21, 16, v43
    v_sub_f32 v21, v67, v21
    v_mul_f32 v83, v21, v20
    v_lshlrev_b32 v21, 16, v54
    v_mul_f32 v21, v21, v23
    v_fmac_f32 v67, v83, v21
    s_add_u32 m0, s63, 81920
    s_nop 0
    buffer_load_dwordx4 v13, s[68:71], s62 offen lds
    s_add_u32 s62, s62, 57344
    v_lshlrev_b32 v68, 16, v30
    v_and_b32 v20, s59, v44
    v_rcp_f32 v20, v20
    v_lshlrev_b32 v21, 16, v44
    v_sub_f32 v21, v68, v21
    v_mul_f32 v84, v21, v20
    v_and_b32 v21, s59, v53
    v_mul_f32 v21, v21, v23
    v_fmac_f32 v68, v84, v21
    s_add_u32 m0, s63, 36864
    s_nop 0
    buffer_load_dwordx4 v13, s[64:67], s62 offen lds
    v_and_b32 v69, s59, v30
    v_and_b32 v20, s59, v45
    v_rcp_f32 v20, v20
    v_lshlrev_b32 v21, 16, v45
    v_sub_f32 v21, v69, v21
    v_mul_f32 v85, v21, v20
    v_lshlrev_b32 v21, 16, v53
    v_mul_f32 v21, v21, v23
    v_fmac_f32 v69, v85, v21
    s_add_u32 m0, s63, 86016
    s_nop 0
    buffer_load_dwordx4 v13, s[68:71], s62 offen lds
    s_add_u32 s62, s62, 57344
    v_lshlrev_b32 v70, 16, v31
    v_and_b32 v20, s59, v46
    v_rcp_f32 v20, v20
    v_lshlrev_b32 v21, 16, v46
    v_sub_f32 v21, v70, v21
    v_mul_f32 v86, v21, v20
    v_and_b32 v21, s59, v52
    v_mul_f32 v21, v21, v23
    v_fmac_f32 v70, v86, v21
    s_add_u32 m0, s63, 40960
    s_nop 0
    buffer_load_dwordx4 v13, s[64:67], s62 offen lds
    v_and_b32 v71, s59, v31
    v_and_b32 v20, s59, v47
    v_rcp_f32 v20, v20
    v_lshlrev_b32 v21, 16, v47
    v_sub_f32 v21, v71, v21
    v_mul_f32 v87, v21, v20
    v_lshlrev_b32 v21, 16, v52
    v_mul_f32 v21, v21, v23
    v_fmac_f32 v71, v87, v21
    s_add_u32 m0, s63, 90112
    s_nop 0
    buffer_load_dwordx4 v13, s[68:71], s62 offen lds
    s_add_u32 s62, s62, 57344
    s_barrier
    ds_read_b128 v[88:91], v10 offset:0
    ds_read_b128 v[92:95], v10 offset:256
    ds_read_b128 v[96:99], v10 offset:8192
    ds_read_b128 v[100:103], v10 offset:8448
    ds_read_b128 v[104:107], v10 offset:2048
    ds_read_b128 v[108:111], v10 offset:2304
    ds_read_b128 v[112:115], v10 offset:10240
    ds_read_b128 v[116:119], v10 offset:10496
    s_waitcnt lgkmcnt(4)
    v_pk_add_f32 v[88:89], v[88:89], v[96:97]
    v_pk_add_f32 v[90:91], v[90:91], v[98:99]
    v_pk_add_f32 v[92:93], v[92:93], v[100:101]
    v_pk_add_f32 v[94:95], v[94:95], v[102:103]
    v_pk_fma_f32 v[88:89], v[88:89], v[72:73], v[56:57]
    v_pk_fma_f32 v[90:91], v[90:91], v[74:75], v[58:59]
    v_pk_fma_f32 v[92:93], v[92:93], v[76:77], v[60:61]
    v_pk_fma_f32 v[94:95], v[94:95], v[78:79], v[62:63]
    v_cvt_pk_bf16_f32 v24, v88, v89
    v_cvt_pk_bf16_f32 v25, v90, v91
    v_cvt_pk_bf16_f32 v26, v92, v93
    v_cvt_pk_bf16_f32 v27, v94, v95
    buffer_store_dwordx4 v[24:27], v11, s[36:39], s72 offen sc1
    s_waitcnt lgkmcnt(0)
    v_pk_add_f32 v[104:105], v[104:105], v[112:113]
    v_pk_add_f32 v[106:107], v[106:107], v[114:115]
    v_pk_add_f32 v[108:109], v[108:109], v[116:117]
    v_pk_add_f32 v[110:111], v[110:111], v[118:119]
    v_pk_fma_f32 v[104:105], v[104:105], v[80:81], v[64:65]
    v_pk_fma_f32 v[106:107], v[106:107], v[82:83], v[66:67]
    v_pk_fma_f32 v[108:109], v[108:109], v[84:85], v[68:69]
    v_pk_fma_f32 v[110:111], v[110:111], v[86:87], v[70:71]
    v_cvt_pk_bf16_f32 v28, v104, v105
    v_cvt_pk_bf16_f32 v29, v106, v107
    v_cvt_pk_bf16_f32 v30, v108, v109
    v_cvt_pk_bf16_f32 v31, v110, v111
    buffer_store_dwordx4 v[28:31], v11, s[36:39], s73 offen sc1
    v_or_b32 v0, 0x100, v0
    s_branch L_p2
L_conv:
    s_lshl_b32 s60, s52, 6
    s_lshl_b32 s61, s53, 3
    s_add_u32 s60, s60, s61
    v_lshrrev_b32 v6, 5, v0
    v_add_u32 v6, s60, v6
    v_and_b32 v7, 31, v0
    v_lshlrev_b32 v3, 4, v7
    v_lshl_add_u32 v3, v6, 10, v3
    buffer_load_dwordx4 v[152:155], v3, s[32:35], 0 offen
    buffer_load_dwordx4 v[156:159], v3, s[32:35], 0 offen offset:512
    s_lshr_b32 s72, s88, 1
    s_and_b32 s73, s88, 1
    s_lshl_b32 s62, s101, 1
    s_add_u32 s62, s62, s72
    s_lshl_b32 s62, s62, 12
    s_add_u32 s44, s12, s62
    s_addc_u32 s45, s13, 0
    s_mov_b32 s46, 4096
    s_mov_b32 s47, 0x00020000
    s_mul_i32 s54, s88, 4224
    s_add_u32 s54, s54, 98304
    s_lshl_b32 s62, s73, 2
    v_lshl_add_u32 v3, v2, 2, s62
    v_subrev_u32 v3, 32, v3
    s_add_u32 m0, s54, 32
    v_add_u32 v5, s62, v4
    buffer_load_dwordx4 v5, s[44:47], 0 offen offset:0 lds
    buffer_load_dwordx4 v5, s[44:47], 0 offen offset:1024 lds
    buffer_load_dwordx4 v5, s[44:47], 0 offen offset:2048 lds
    buffer_load_dwordx4 v5, s[44:47], 0 offen offset:3072 lds
    s_mov_b32 m0, s54
    s_mul_i32 s54, s72, 8448
    buffer_load_dword v3, s[44:47], 0 offen lds
    s_add_u32 s54, s54, 98304
    v_lshlrev_b32 v21, 13, v8
    v_lshl_add_u32 v21, v9, 4, v21
    v_add_u32 v21, 2097152, v21
    v_lshlrev_b32 v6, 2, v6
    v_lshl_add_u32 v6, v7, 23, v6
    v_add_u32 v6, 4194304, v6
    v_add_u32 v23, 17408, v10
    v_mov_b32 v9, 147456
    v_mov_b32 v10, 0
    v_mov_b32 v11, 0
    ds_write_b64 v9, v[10:11]
    s_mul_i32 s53, s72, 4608
    s_add_u32 s53, s53, 132096
    v_lshl_add_u32 v8, v2, 3, s53
    ds_write_b64 v8, v[10:11]
    v_and_b32 v9, 15, v2
    v_lshrrev_b32 v10, 4, v2
    v_add_u32 v11, 1, v9
    v_and_b32 v12, 1, v11
    v_lshlrev_b32 v12, 1, v12
    v_lshrrev_b32 v11, 1, v11
    v_and_b32 v13, 1, v11
    v_mul_u32_u24 v13, 4224, v13
    v_and_b32 v11, 14, v11
    v_lshl_add_u32 v11, v10, 4, v11
    v_lshl_add_u32 v13, v11, 2, v13
    s_lshl_b32 s62, s73, 8
    s_add_u32 s62, s62, s54
    v_add_u32 v13, s62, v13
    v_lshlrev_b32 v14, 1, v9
    v_lshlrev_b32 v15, 2, v10
    v_sub_u32 v14, v14, v15
    s_lshl_b32 s63, s73, 4
    s_sub_u32 s63, 33, s63
    v_add_u32 v14, s63, v14
    v_subrev_u32 v15, 0, v14
    v_bfe_u32 v20, v15, 4, 1
    v_xor_b32 v15, v15, v20
    v_lshl_add_u32 v16, v15, 4, s53
    v_subrev_u32 v15, 1, v14
    v_bfe_u32 v20, v15, 4, 1
    v_xor_b32 v15, v15, v20
    v_lshl_add_u32 v17, v15, 4, s53
    v_subrev_u32 v15, 2, v14
    v_bfe_u32 v20, v15, 4, 1
    v_xor_b32 v15, v15, v20
    v_lshl_add_u32 v18, v15, 4, s53
    v_subrev_u32 v15, 3, v14
    v_bfe_u32 v20, v15, 4, 1
    v_xor_b32 v15, v15, v20
    v_lshl_add_u32 v19, v15, 4, s53
    v_lshrrev_b32 v14, 5, v2
    v_lshlrev_b32 v14, 7, v14
    v_xor_b32 v14, v14, v4
    s_lshl_b32 s63, s88, 13
    s_add_u32 s63, s63, 98304
    v_add_u32 v22, s63, v14
    s_mov_b32 s60, 0x05040100
    s_mov_b32 s61, 0x07060302
    s_waitcnt vmcnt(0) lgkmcnt(0)
    s_add_u32 s100, s100, 1
    s_barrier
    ds_read2_b32 v[160:161], v23 offset0:0 offset1:32
    ds_read2_b32 v[162:163], v23 offset0:64 offset1:96
    ds_read2_b32 v[164:165], v23 offset0:128 offset1:160
    ds_read2_b32 v[166:167], v23 offset0:192 offset1:224
    v_mov_b32 v14, 0
    v_mov_b32 v15, 0
    v_mov_b32 v20, 0x3f803f80
    v_dot2c_f32_bf16 v14, v152, v20
    v_dot2c_f32_bf16 v15, v152, v152
    v_dot2c_f32_bf16 v14, v153, v20
    v_dot2c_f32_bf16 v15, v153, v153
    v_dot2c_f32_bf16 v14, v154, v20
    v_dot2c_f32_bf16 v15, v154, v154
    v_dot2c_f32_bf16 v14, v155, v20
    v_dot2c_f32_bf16 v15, v155, v155
    v_dot2c_f32_bf16 v14, v156, v20
    v_dot2c_f32_bf16 v15, v156, v156
    v_dot2c_f32_bf16 v14, v157, v20
    v_dot2c_f32_bf16 v15, v157, v157
    v_dot2c_f32_bf16 v14, v158, v20
    v_dot2c_f32_bf16 v15, v158, v158
    v_dot2c_f32_bf16 v14, v159, v20
    v_dot2c_f32_bf16 v15, v159, v159
    s_waitcnt lgkmcnt(0)
    v_perm_b32 v168, v161, v160, s60
    v_perm_b32 v169, v163, v162, s60
    v_perm_b32 v170, v165, v164, s60
    v_perm_b32 v171, v167, v166, s60
    v_perm_b32 v172, v161, v160, s61
    v_perm_b32 v173, v163, v162, s61
    v_perm_b32 v174, v165, v164, s61
    v_perm_b32 v175, v167, v166, s61
    buffer_store_dwordx4 v[168:171], v21, s[48:51], 0 offen sc1
    buffer_store_dwordx4 v[172:175], v21, s[48:51], s57 offen sc1
    v_add_f32_dpp v14, v14, v14 quad_perm:[1,0,3,2] row_mask:0xf bank_mask:0xf
    v_add_f32_dpp v15, v15, v15 quad_perm:[1,0,3,2] row_mask:0xf bank_mask:0xf
    s_nop 0
    v_add_f32_dpp v14, v14, v14 quad_perm:[2,3,0,1] row_mask:0xf bank_mask:0xf
    v_add_f32_dpp v15, v15, v15 quad_perm:[2,3,0,1] row_mask:0xf bank_mask:0xf
    s_nop 0
    v_add_f32_dpp v14, v14, v14 row_half_mirror row_mask:0xf bank_mask:0xf
    v_add_f32_dpp v15, v15, v15 row_half_mirror row_mask:0xf bank_mask:0xf
    s_nop 0
    v_add_f32_dpp v14, v14, v14 row_mirror row_mask:0xf bank_mask:0xf
    v_add_f32_dpp v15, v15, v15 row_mirror row_mask:0xf bank_mask:0xf
    s_nop 0
    v_mov_b32 v20, v14
    v_mov_b32 v23, v15
    s_nop 1
    v_permlane16_swap_b32 v14, v20
    v_permlane16_swap_b32 v15, v23
    v_add_f32 v14, v14, v20
    v_add_f32 v15, v15, v23
    v_mul_f32 v14, 0x3b000000, v14
    v_mul_f32 v15, 0x3b000000, v15
    v_fma_f32 v15, -v14, v14, v15
    v_max_f32 v15, 0, v15
    v_cvt_pk_bf16_f32 v20, v15, v15
    v_lshlrev_b32 v20, 16, v20
    v_add_f32 v20, 0x3727c5ac, v20
    v_cvt_pk_bf16_f32 v20, v20, v20
    v_lshlrev_b32 v20, 16, v20
    v_sqrt_f32 v20, v20
    s_nop 0
    v_cvt_pk_bf16_f32 v23, v14, v20
    buffer_store_dword v23, v6, s[48:51], 0 offen sc1
    ds_read_b64 v[24:25], v13 offset:0
    ds_read_b64 v[26:27], v13 offset:8
    ds_read_b64 v[28:29], v13 offset:16
    ds_read_b64 v[30:31], v13 offset:24
    ds_read_b64 v[32:33], v13 offset:32
    ds_read_b64 v[34:35], v13 offset:40
    ds_read_b64 v[36:37], v13 offset:48
    ds_read_b64 v[38:39], v13 offset:56
    ds_read_b32 v184, v13 offset:64
    ds_read_b64 v[40:41], v13 offset:512
    ds_read_b64 v[42:43], v13 offset:520
    ds_read_b64 v[44:45], v13 offset:528
    ds_read_b64 v[46:47], v13 offset:536
    ds_read_b64 v[48:49], v13 offset:544
    ds_read_b64 v[50:51], v13 offset:552
    ds_read_b64 v[52:53], v13 offset:560
    ds_read_b64 v[54:55], v13 offset:568
    ds_read_b32 v185, v13 offset:576
    s_waitcnt lgkmcnt(9)
    v_alignbyte_b32 v24, v25, v24, v12
    v_alignbyte_b32 v25, v26, v25, v12
    v_alignbyte_b32 v26, v27, v26, v12
    v_alignbyte_b32 v27, v28, v27, v12
    v_alignbyte_b32 v28, v29, v28, v12
    v_alignbyte_b32 v29, v30, v29, v12
    v_alignbyte_b32 v30, v31, v30, v12
    v_alignbyte_b32 v31, v32, v31, v12
    v_alignbyte_b32 v32, v33, v32, v12
    v_alignbyte_b32 v33, v34, v33, v12
    v_alignbyte_b32 v34, v35, v34, v12
    v_alignbyte_b32 v35, v36, v35, v12
    v_alignbyte_b32 v36, v37, v36, v12
    v_alignbyte_b32 v37, v38, v37, v12
    v_alignbyte_b32 v38, v39, v38, v12
    v_alignbyte_b32 v39, v184, v39, v12
    ds_read_b64 v[56:57], v13 offset:1024
    ds_read_b64 v[58:59], v13 offset:1032
    ds_read_b64 v[60:61], v13 offset:1040
    ds_read_b64 v[62:63], v13 offset:1048
    ds_read_b64 v[64:65], v13 offset:1056
    ds_read_b64 v[66:67], v13 offset:1064
    ds_read_b64 v[68:69], v13 offset:1072
    ds_read_b64 v[70:71], v13 offset:1080
    ds_read_b32 v186, v13 offset:1088
    s_waitcnt lgkmcnt(9)
    v_alignbyte_b32 v40, v41, v40, v12
    v_alignbyte_b32 v41, v42, v41, v12
    v_alignbyte_b32 v42, v43, v42, v12
    v_alignbyte_b32 v43, v44, v43, v12
    v_alignbyte_b32 v44, v45, v44, v12
    v_alignbyte_b32 v45, v46, v45, v12
    v_alignbyte_b32 v46, v47, v46, v12
    v_alignbyte_b32 v47, v48, v47, v12
    v_alignbyte_b32 v48, v49, v48, v12
    v_alignbyte_b32 v49, v50, v49, v12
    v_alignbyte_b32 v50, v51, v50, v12
    v_alignbyte_b32 v51, v52, v51, v12
    v_alignbyte_b32 v52, v53, v52, v12
    v_alignbyte_b32 v53, v54, v53, v12
    v_alignbyte_b32 v54, v55, v54, v12
    v_alignbyte_b32 v55, v185, v55, v12
    ds_read_b64 v[72:73], v13 offset:1536
    ds_read_b64 v[74:75], v13 offset:1544
    ds_read_b64 v[76:77], v13 offset:1552
    ds_read_b64 v[78:79], v13 offset:1560
    ds_read_b64 v[80:81], v13 offset:1568
    ds_read_b64 v[82:83], v13 offset:1576
    ds_read_b64 v[84:85], v13 offset:1584
    ds_read_b64 v[86:87], v13 offset:1592
    ds_read_b32 v187, v13 offset:1600
    s_waitcnt lgkmcnt(9)
    v_alignbyte_b32 v56, v57, v56, v12
    v_alignbyte_b32 v57, v58, v57, v12
    v_alignbyte_b32 v58, v59, v58, v12
    v_alignbyte_b32 v59, v60, v59, v12
    v_alignbyte_b32 v60, v61, v60, v12
    v_alignbyte_b32 v61, v62, v61, v12
    v_alignbyte_b32 v62, v63, v62, v12
    v_alignbyte_b32 v63, v64, v63, v12
    v_alignbyte_b32 v64, v65, v64, v12
    v_alignbyte_b32 v65, v66, v65, v12
    v_alignbyte_b32 v66, v67, v66, v12
    v_alignbyte_b32 v67, v68, v67, v12
    v_alignbyte_b32 v68, v69, v68, v12
    v_alignbyte_b32 v69, v70, v69, v12
    v_alignbyte_b32 v70, v71, v70, v12
    v_alignbyte_b32 v71, v186, v71, v12
    ds_read_b64 v[88:89], v13 offset:2048
    ds_read_b64 v[90:91], v13 offset:2056
    ds_read_b64 v[92:93], v13 offset:2064
    ds_read_b64 v[94:95], v13 offset:2072
    ds_read_b64 v[96:97], v13 offset:2080
    ds_read_b64 v[98:99], v13 offset:2088
    ds_read_b64 v[100:101], v13 offset:2096
    ds_read_b64 v[102:103], v13 offset:2104
    ds_read_b32 v188, v13 offset:2112
    s_waitcnt lgkmcnt(9)
    v_alignbyte_b32 v72, v73, v72, v12
    v_alignbyte_b32 v73, v74, v73, v12
    v_alignbyte_b32 v74, v75, v74, v12
    v_alignbyte_b32 v75, v76, v75, v12
    v_alignbyte_b32 v76, v77, v76, v12
    v_alignbyte_b32 v77, v78, v77, v12
    v_alignbyte_b32 v78, v79, v78, v12
    v_alignbyte_b32 v79, v80, v79, v12
    v_alignbyte_b32 v80, v81, v80, v12
    v_alignbyte_b32 v81, v82, v81, v12
    v_alignbyte_b32 v82, v83, v82, v12
    v_alignbyte_b32 v83, v84, v83, v12
    v_alignbyte_b32 v84, v85, v84, v12
    v_alignbyte_b32 v85, v86, v85, v12
    v_alignbyte_b32 v86, v87, v86, v12
    v_alignbyte_b32 v87, v187, v87, v12
    ds_read_b64 v[104:105], v13 offset:2560
    ds_read_b64 v[106:107], v13 offset:2568
    ds_read_b64 v[108:109], v13 offset:2576
    ds_read_b64 v[110:111], v13 offset:2584
    ds_read_b64 v[112:113], v13 offset:2592
    ds_read_b64 v[114:115], v13 offset:2600
    ds_read_b64 v[116:117], v13 offset:2608
    ds_read_b64 v[118:119], v13 offset:2616
    ds_read_b32 v189, v13 offset:2624
    s_waitcnt lgkmcnt(9)
    v_alignbyte_b32 v88, v89, v88, v12
    v_alignbyte_b32 v89, v90, v89, v12
    v_alignbyte_b32 v90, v91, v90, v12
    v_alignbyte_b32 v91, v92, v91, v12
    v_alignbyte_b32 v92, v93, v92, v12
    v_alignbyte_b32 v93, v94, v93, v12
    v_alignbyte_b32 v94, v95, v94, v12
    v_alignbyte_b32 v95, v96, v95, v12
    v_alignbyte_b32 v96, v97, v96, v12
    v_alignbyte_b32 v97, v98, v97, v12
    v_alignbyte_b32 v98, v99, v98, v12
    v_alignbyte_b32 v99, v100, v99, v12
    v_alignbyte_b32 v100, v101, v100, v12
    v_alignbyte_b32 v101, v102, v101, v12
    v_alignbyte_b32 v102, v103, v102, v12
    v_alignbyte_b32 v103, v188, v103, v12
    ds_read_b64 v[120:121], v13 offset:3072
    ds_read_b64 v[122:123], v13 offset:3080
    ds_read_b64 v[124:125], v13 offset:3088
    ds_read_b64 v[126:127], v13 offset:3096
    ds_read_b64 v[128:129], v13 offset:3104
    ds_read_b64 v[130:131], v13 offset:3112
    ds_read_b64 v[132:133], v13 offset:3120
    ds_read_b64 v[134:135], v13 offset:3128
    ds_read_b32 v190, v13 offset:3136
    s_waitcnt lgkmcnt(9)
    v_alignbyte_b32 v104, v105, v104, v12
    v_alignbyte_b32 v105, v106, v105, v12
    v_alignbyte_b32 v106, v107, v106, v12
    v_alignbyte_b32 v107, v108, v107, v12
    v_alignbyte_b32 v108, v109, v108, v12
    v_alignbyte_b32 v109, v110, v109, v12
    v_alignbyte_b32 v110, v111, v110, v12
    v_alignbyte_b32 v111, v112, v111, v12
    v_alignbyte_b32 v112, v113, v112, v12
    v_alignbyte_b32 v113, v114, v113, v12
    v_alignbyte_b32 v114, v115, v114, v12
    v_alignbyte_b32 v115, v116, v115, v12
    v_alignbyte_b32 v116, v117, v116, v12
    v_alignbyte_b32 v117, v118, v117, v12
    v_alignbyte_b32 v118, v119, v118, v12
    v_alignbyte_b32 v119, v189, v119, v12
    ds_read_b64 v[136:137], v13 offset:3584
    ds_read_b64 v[138:139], v13 offset:3592
    ds_read_b64 v[140:141], v13 offset:3600
    ds_read_b64 v[142:143], v13 offset:3608
    ds_read_b64 v[144:145], v13 offset:3616
    ds_read_b64 v[146:147], v13 offset:3624
    ds_read_b64 v[148:149], v13 offset:3632
    ds_read_b64 v[150:151], v13 offset:3640
    ds_read_b32 v191, v13 offset:3648
    s_waitcnt lgkmcnt(9)
    v_alignbyte_b32 v120, v121, v120, v12
    v_alignbyte_b32 v121, v122, v121, v12
    v_alignbyte_b32 v122, v123, v122, v12
    v_alignbyte_b32 v123, v124, v123, v12
    v_alignbyte_b32 v124, v125, v124, v12
    v_alignbyte_b32 v125, v126, v125, v12
    v_alignbyte_b32 v126, v127, v126, v12
    v_alignbyte_b32 v127, v128, v127, v12
    v_alignbyte_b32 v128, v129, v128, v12
    v_alignbyte_b32 v129, v130, v129, v12
    v_alignbyte_b32 v130, v131, v130, v12
    v_alignbyte_b32 v131, v132, v131, v12
    v_alignbyte_b32 v132, v133, v132, v12
    v_alignbyte_b32 v133, v134, v133, v12
    v_alignbyte_b32 v134, v135, v134, v12
    v_alignbyte_b32 v135, v190, v135, v12
    s_waitcnt lgkmcnt(0)
    v_alignbyte_b32 v136, v137, v136, v12
    v_alignbyte_b32 v137, v138, v137, v12
    v_alignbyte_b32 v138, v139, v138, v12
    v_alignbyte_b32 v139, v140, v139, v12
    v_alignbyte_b32 v140, v141, v140, v12
    v_alignbyte_b32 v141, v142, v141, v12
    v_alignbyte_b32 v142, v143, v142, v12
    v_alignbyte_b32 v143, v144, v143, v12
    v_alignbyte_b32 v144, v145, v144, v12
    v_alignbyte_b32 v145, v146, v145, v12
    v_alignbyte_b32 v146, v147, v146, v12
    v_alignbyte_b32 v147, v148, v147, v12
    v_alignbyte_b32 v148, v149, v148, v12
    v_alignbyte_b32 v149, v150, v149, v12
    v_alignbyte_b32 v150, v151, v150, v12
    v_alignbyte_b32 v151, v191, v151, v12
    s_mul_i32 s90, s74, 128
    s_add_u32 s90, s90, 0
    s_lshl_b32 s91, s74, 2
    s_add_u32 s91, s91, 32768
    v_mov_b32 v250, -1
    v_writelane_b32 v250, s90, 0
    v_writelane_b32 v250, s91, 1
    s_and_b32 s90, s2, 7
    s_mul_i32 s90, s90, 4096
    v_and_b32 v243, 31, v0
    v_mul_u32_u24 v243, 128, v243
    v_add_u32 v243, s90, v243
    v_mov_b32 v244, 147456
    v_mov_b32 v251, 1
    s_mov_b64 exec, 1
    s_waitcnt vmcnt(0)
    ds_add_rtn_u32 v251, v244, v251
    s_mov_b64 exec, -1
    s_waitcnt lgkmcnt(0)
    v_readfirstlane_b32 s90, v251
    s_cmp_lg_u32 s90, 7
    s_cbranch_scc1 L_nopoll_9
    v_mov_b32 v251, s100
    buffer_store_dword v251, v250, s[84:87], 0 offen sc1
L_poll_10:
    buffer_load_dword v251, v243, s[84:87], 0 offen offset:0 sc1
    s_sub_u32 s89, s89, 1
    s_cbranch_scc1 L_pollx_11
L_polly_12:
    s_waitcnt vmcnt(0)
    v_cmp_ne_u32 vcc, s100, v251
    s_cbranch_vccnz L_poll_10
L_pollx_11:
    s_max_i32 s89, s89, 0
    s_lshl_b32 s90, s101, 13
    s_mov_b32 m0, 132608
    s_nop 0
    buffer_load_dwordx4 v4, s[48:51], s90 offen offset:0 sc1 lds
    buffer_load_dwordx4 v4, s[48:51], s90 offen offset:1024 sc1 lds
    buffer_load_dwordx4 v4, s[48:51], s90 offen offset:2048 sc1 lds
    buffer_load_dwordx4 v4, s[48:51], s90 offen offset:3072 sc1 lds
    s_add_u32 s90, s90, 4096
    s_mov_b32 m0, 137216
    s_nop 0
    buffer_load_dwordx4 v4, s[48:51], s90 offen offset:0 sc1 lds
    buffer_load_dwordx4 v4, s[48:51], s90 offen offset:1024 sc1 lds
    buffer_load_dwordx4 v4, s[48:51], s90 offen offset:2048 sc1 lds
    buffer_load_dwordx4 v4, s[48:51], s90 offen offset:3072 sc1 lds
    s_mov_b32 s91, 32768
L_poll_13:
    buffer_load_dwordx4 v[244:247], v4, s[84:87], s91 offen sc1
    s_sub_u32 s89, s89, 1
    s_cbranch_scc1 L_pollx_14
L_polly_15:
    s_waitcnt vmcnt(0)
    v_xor_b32 v244, s100, v244
    v_xor_b32 v245, s100, v245
    v_xor_b32 v246, s100, v246
    v_xor_b32 v247, s100, v247
    v_or_b32 v244, v244, v245
    v_or3_b32 v244, v244, v246, v247
    v_cmp_ne_u32 vcc, 0, v244
    s_cbranch_vccnz L_poll_13
L_pollx_14:
    s_max_i32 s89, s89, 0
    s_waitcnt vmcnt(0)
L_nopoll_9:
    s_barrier
    s_setprio 2
    ds_read_b128 v[152:155], v16 offset:0
    ds_read_b128 v[156:159], v16 offset:512
    ds_read_b128 v[160:163], v16 offset:1024
    ds_read_b128 v[164:167], v16 offset:1536
    ds_read_b128 v[168:171], v16 offset:2048
    ds_read_b128 v[172:175], v16 offset:2560
    ds_read_b128 v[176:179], v16 offset:3072
    ds_read_b128 v[180:183], v16 offset:3584
    s_waitcnt lgkmcnt(7)
    v_mfma_f32_16x16x32_bf16 v[216:219], v[24:27], v[152:155], 0
    v_mfma_f32_16x16x32_bf16 v[220:223], v[40:43], v[152:155], 0
    v_mfma_f32_16x16x32_bf16 v[224:227], v[56:59], v[152:155], 0
    v_mfma_f32_16x16x32_bf16 v[228:231], v[72:75], v[152:155], 0
    v_mfma_f32_16x16x32_bf16 v[232:235], v[88:91], v[152:155], 0
    v_mfma_f32_16x16x32_bf16 v[236:239], v[104:107], v[152:155], 0
    v_mfma_f32_16x16x32_bf16 v[240:243], v[120:123], v[152:155], 0
    v_mfma_f32_16x16x32_bf16 v[244:247], v[136:139], v[152:155], 0
    s_waitcnt lgkmcnt(6)
    v_mfma_f32_16x16x32_bf16 v[220:223], v[24:27], v[156:159], v[220:223]
    ds_read_b128 v[184:187], v17 offset:0
    v_mfma_f32_16x16x32_bf16 v[224:227], v[40:43], v[156:159], v[224:227]
    v_mfma_f32_16x16x32_bf16 v[228:231], v[56:59], v[156:159], v[228:231]
    ds_read_b128 v[188:191], v17 offset:512
    v_mfma_f32_16x16x32_bf16 v[232:235], v[72:75], v[156:159], v[232:235]
    v_mfma_f32_16x16x32_bf16 v[236:239], v[88:91], v[156:159], v[236:239]
    ds_read_b128 v[192:195], v17 offset:1024
    v_mfma_f32_16x16x32_bf16 v[240:243], v[104:107], v[156:159], v[240:243]
    v_mfma_f32_16x16x32_bf16 v[244:247], v[120:123], v[156:159], v[244:247]
    ds_read_b128 v[196:199], v17 offset:1536
    s_waitcnt lgkmcnt(9)
    v_mfma_f32_16x16x32_bf16 v[224:227], v[24:27], v[160:163], v[224:227]
    ds_read_b128 v[200:203], v17 offset:2048
    v_mfma_f32_16x16x32_bf16 v[228:231], v[40:43], v[160:163], v[228:231]
    v_mfma_f32_16x16x32_bf16 v[232:235], v[56:59], v[160:163], v[232:235]
    ds_read_b128 v[204:207], v17 offset:2560
    v_mfma_f32_16x16x32_bf16 v[236:239], v[72:75], v[160:163], v[236:239]
    v_mfma_f32_16x16x32_bf16 v[240:243], v[88:91], v[160:163], v[240:243]
    ds_read_b128 v[208:211], v17 offset:3072
    v_mfma_f32_16x16x32_bf16 v[244:247], v[104:107], v[160:163], v[244:247]
    s_waitcnt lgkmcnt(11)
    v_mfma_f32_16x16x32_bf16 v[228:231], v[24:27], v[164:167], v[228:231]
    ds_read_b128 v[212:215], v17 offset:3584
    v_mfma_f32_16x16x32_bf16 v[232:235], v[40:43], v[164:167], v[232:235]
    v_mfma_f32_16x16x32_bf16 v[236:239], v[56:59], v[164:167], v[236:239]
    v_mfma_f32_16x16x32_bf16 v[240:243], v[72:75], v[164:167], v[240:243]
    v_mfma_f32_16x16x32_bf16 v[244:247], v[88:91], v[164:167], v[244:247]
    s_waitcnt lgkmcnt(11)
    v_mfma_f32_16x16x32_bf16 v[232:235], v[24:27], v[168:171], v[232:235]
    v_mfma_f32_16x16x32_bf16 v[236:239], v[40:43], v[168:171], v[236:239]
    v_mfma_f32_16x16x32_bf16 v[240:243], v[56:59], v[168:171], v[240:243]
    v_mfma_f32_16x16x32_bf16 v[244:247], v[72:75], v[168:171], v[244:247]
    s_waitcnt lgkmcnt(10)
    v_mfma_f32_16x16x32_bf16 v[236:239], v[24:27], v[172:175], v[236:239]
    v_mfma_f32_16x16x32_bf16 v[240:243], v[40:43], v[172:175], v[240:243]
    v_mfma_f32_16x16x32_bf16 v[244:247], v[56:59], v[172:175], v[244:247]
    s_waitcnt lgkmcnt(9)
    v_mfma_f32_16x16x32_bf16 v[240:243], v[24:27], v[176:179], v[240:243]
    v_mfma_f32_16x16x32_bf16 v[244:247], v[40:43], v[176:179], v[244:247]
    s_waitcnt lgkmcnt(8)
    v_mfma_f32_16x16x32_bf16 v[244:247], v[24:27], v[180:183], v[244:247]
    s_waitcnt lgkmcnt(0)
    v_mfma_f32_16x16x32_bf16 v[216:219], v[28:31], v[184:187], v[216:219]
    v_mfma_f32_16x16x32_bf16 v[220:223], v[44:47], v[184:187], v[220:223]
    v_mfma_f32_16x16x32_bf16 v[224:227], v[60:63], v[184:187], v[224:227]
    v_mfma_f32_16x16x32_bf16 v[228:231], v[76:79], v[184:187], v[228:231]
    v_mfma_f32_16x16x32_bf16 v[232:235], v[92:95], v[184:187], v[232:235]
    v_mfma_f32_16x16x32_bf16 v[236:239], v[108:111], v[184:187], v[236:239]
    v_mfma_f32_16x16x32_bf16 v[240:243], v[124:127], v[184:187], v[240:243]
    v_mfma_f32_16x16x32_bf16 v[244:247], v[140:143], v[184:187], v[244:247]
    v_mfma_f32_16x16x32_bf16 v[220:223], v[28:31], v[188:191], v[220:223]
    ds_read_b128 v[152:155], v18 offset:0
    v_mfma_f32_16x16x32_bf16 v[224:227], v[44:47], v[188:191], v[224:227]
    v_mfma_f32_16x16x32_bf16 v[228:231], v[60:63], v[188:191], v[228:231]
    ds_read_b128 v[156:159], v18 offset:512
    v_mfma_f32_16x16x32_bf16 v[232:235], v[76:79], v[188:191], v[232:235]
    v_mfma_f32_16x16x32_bf16 v[236:239], v[92:95], v[188:191], v[236:239]
    ds_read_b128 v[160:163], v18 offset:1024
    v_mfma_f32_16x16x32_bf16 v[240:243], v[108:111], v[188:191], v[240:243]
    v_mfma_f32_16x16x32_bf16 v[244:247], v[124:127], v[188:191], v[244:247]
    ds_read_b128 v[164:167], v18 offset:1536
    v_mfma_f32_16x16x32_bf16 v[224:227], v[28:31], v[192:195], v[224:227]
    ds_read_b128 v[168:171], v18 offset:2048
    v_mfma_f32_16x16x32_bf16 v[228:231], v[44:47], v[192:195], v[228:231]
    v_mfma_f32_16x16x32_bf16 v[232:235], v[60:63], v[192:195], v[232:235]
    ds_read_b128 v[172:175], v18 offset:2560
    v_mfma_f32_16x16x32_bf16 v[236:239], v[76:79], v[192:195], v[236:239]
    v_mfma_f32_16x16x32_bf16 v[240:243], v[92:95], v[192:195], v[240:243]
    ds_read_b128 v[176:179], v18 offset:3072
    v_mfma_f32_16x16x32_bf16 v[244:247], v[108:111], v[192:195], v[244:247]
    v_mfma_f32_16x16x32_bf16 v[228:231], v[28:31], v[196:199], v[228:231]
    ds_read_b128 v[180:183], v18 offset:3584
    v_mfma_f32_16x16x32_bf16 v[232:235], v[44:47], v[196:199], v[232:235]
    v_mfma_f32_16x16x32_bf16 v[236:239], v[60:63], v[196:199], v[236:239]
    v_mfma_f32_16x16x32_bf16 v[240:243], v[76:79], v[196:199], v[240:243]
    v_mfma_f32_16x16x32_bf16 v[244:247], v[92:95], v[196:199], v[244:247]
    v_mfma_f32_16x16x32_bf16 v[232:235], v[28:31], v[200:203], v[232:235]
    v_mfma_f32_16x16x32_bf16 v[236:239], v[44:47], v[200:203], v[236:239]
    v_mfma_f32_16x16x32_bf16 v[240:243], v[60:63], v[200:203], v[240:243]
    v_mfma_f32_16x16x32_bf16 v[244:247], v[76:79], v[200:203], v[244:247]
    v_mfma_f32_16x16x32_bf16 v[236:239], v[28:31], v[204:207], v[236:239]
    v_mfma_f32_16x16x32_bf16 v[240:243], v[44:47], v[204:207], v[240:243]
    v_mfma_f32_16x16x32_bf16 v[244:247], v[60:63], v[204:207], v[244:247]
    v_mfma_f32_16x16x32_bf16 v[240:243], v[28:31], v[208:211], v[240:243]
    v_mfma_f32_16x16x32_bf16 v[244:247], v[44:47], v[208:211], v[244:247]
    v_mfma_f32_16x16x32_bf16 v[244:247], v[28:31], v[212:215], v[244:247]
    s_waitcnt lgkmcnt(0)
    v_mfma_f32_16x16x32_bf16 v[216:219], v[32:35], v[152:155], v[216:219]
    v_mfma_f32_16x16x32_bf16 v[220:223], v[48:51], v[152:155], v[220:223]
    v_mfma_f32_16x16x32_bf16 v[224:227], v[64:67], v[152:155], v[224:227]
    v_mfma_f32_16x16x32_bf16 v[228:231], v[80:83], v[152:155], v[228:231]
    v_mfma_f32_16x16x32_bf16 v[232:235], v[96:99], v[152:155], v[232:235]
    v_mfma_f32_16x16x32_bf16 v[236:239], v[112:115], v[152:155], v[236:239]
    v_mfma_f32_16x16x32_bf16 v[240:243], v[128:131], v[152:155], v[240:243]
    v_mfma_f32_16x16x32_bf16 v[244:247], v[144:147], v[152:155], v[244:247]
    v_mfma_f32_16x16x32_bf16 v[220:223], v[32:35], v[156:159], v[220:223]
    ds_read_b128 v[184:187], v19 offset:0
    v_mfma_f32_16x16x32_bf16 v[224:227], v[48:51], v[156:159], v[224:227]
    v_mfma_f32_16x16x32_bf16 v[228:231], v[64:67], v[156:159], v[228:231]
    ds_read_b128 v[188:191], v19 offset:512
    v_mfma_f32_16x16x32_bf16 v[232:235], v[80:83], v[156:159], v[232:235]
    v_mfma_f32_16x16x32_bf16 v[236:239], v[96:99], v[156:159], v[236:239]
    ds_read_b128 v[192:195], v19 offset:1024
    v_mfma_f32_16x16x32_bf16 v[240:243], v[112:115], v[156:159], v[240:243]
    v_mfma_f32_16x16x32_bf16 v[244:247], v[128:131], v[156:159], v[244:247]
    ds_read_b128 v[196:199], v19 offset:1536
    v_mfma_f32_16x16x32_bf16 v[224:227], v[32:35], v[160:163], v[224:227]
    ds_read_b128 v[200:203], v19 offset:2048
    v_mfma_f32_16x16x32_bf16 v[228:231], v[48:51], v[160:163], v[228:231]
    v_mfma_f32_16x16x32_bf16 v[232:235], v[64:67], v[160:163], v[232:235]
    ds_read_b128 v[204:207], v19 offset:2560
    v_mfma_f32_16x16x32_bf16 v[236:239], v[80:83], v[160:163], v[236:239]
    v_mfma_f32_16x16x32_bf16 v[240:243], v[96:99], v[160:163], v[240:243]
    ds_read_b128 v[208:211], v19 offset:3072
    v_mfma_f32_16x16x32_bf16 v[244:247], v[112:115], v[160:163], v[244:247]
    v_mfma_f32_16x16x32_bf16 v[228:231], v[32:35], v[164:167], v[228:231]
    ds_read_b128 v[212:215], v19 offset:3584
    v_mfma_f32_16x16x32_bf16 v[232:235], v[48:51], v[164:167], v[232:235]
    v_mfma_f32_16x16x32_bf16 v[236:239], v[64:67], v[164:167], v[236:239]
    v_mfma_f32_16x16x32_bf16 v[240:243], v[80:83], v[164:167], v[240:243]
    v_mfma_f32_16x16x32_bf16 v[244:247], v[96:99], v[164:167], v[244:247]
    v_mfma_f32_16x16x32_bf16 v[232:235], v[32:35], v[168:171], v[232:235]
    v_mfma_f32_16x16x32_bf16 v[236:239], v[48:51], v[168:171], v[236:239]
    v_mfma_f32_16x16x32_bf16 v[240:243], v[64:67], v[168:171], v[240:243]
    v_mfma_f32_16x16x32_bf16 v[244:247], v[80:83], v[168:171], v[244:247]
    v_mfma_f32_16x16x32_bf16 v[236:239], v[32:35], v[172:175], v[236:239]
    v_mfma_f32_16x16x32_bf16 v[240:243], v[48:51], v[172:175], v[240:243]
    v_mfma_f32_16x16x32_bf16 v[244:247], v[64:67], v[172:175], v[244:247]
    v_mfma_f32_16x16x32_bf16 v[240:243], v[32:35], v[176:179], v[240:243]
    v_mfma_f32_16x16x32_bf16 v[244:247], v[48:51], v[176:179], v[244:247]
    v_mfma_f32_16x16x32_bf16 v[244:247], v[32:35], v[180:183], v[244:247]
    s_waitcnt lgkmcnt(0)
    v_mfma_f32_16x16x32_bf16 v[216:219], v[36:39], v[184:187], v[216:219]
    v_mfma_f32_16x16x32_bf16 v[220:223], v[52:55], v[184:187], v[220:223]
    v_mfma_f32_16x16x32_bf16 v[224:227], v[68:71], v[184:187], v[224:227]
    v_mfma_f32_16x16x32_bf16 v[228:231], v[84:87], v[184:187], v[228:231]
    v_mfma_f32_16x16x32_bf16 v[232:235], v[100:103], v[184:187], v[232:235]
    v_mfma_f32_16x16x32_bf16 v[236:239], v[116:119], v[184:187], v[236:239]
    v_mfma_f32_16x16x32_bf16 v[240:243], v[132:135], v[184:187], v[240:243]
    v_mfma_f32_16x16x32_bf16 v[244:247], v[148:151], v[184:187], v[244:247]
    v_mfma_f32_16x16x32_bf16 v[220:223], v[36:39], v[188:191], v[220:223]
    v_mfma_f32_16x16x32_bf16 v[224:227], v[52:55], v[188:191], v[224:227]
    v_mfma_f32_16x16x32_bf16 v[228:231], v[68:71], v[188:191], v[228:231]
    v_mfma_f32_16x16x32_bf16 v[232:235], v[84:87], v[188:191], v[232:235]
    v_mfma_f32_16x16x32_bf16 v[236:239], v[100:103], v[188:191], v[236:239]
    v_mfma_f32_16x16x32_bf16 v[240:243], v[116:119], v[188:191], v[240:243]
    v_mfma_f32_16x16x32_bf16 v[244:247], v[132:135], v[188:191], v[244:247]
    v_mfma_f32_16x16x32_bf16 v[224:227], v[36:39], v[192:195], v[224:227]
    ds_write_b128 v22, v[216:219] offset:0
    v_mfma_f32_16x16x32_bf16 v[228:231], v[52:55], v[192:195], v[228:231]
    v_mfma_f32_16x16x32_bf16 v[232:235], v[68:71], v[192:195], v[232:235]
    v_mfma_f32_16x16x32_bf16 v[236:239], v[84:87], v[192:195], v[236:239]
    v_mfma_f32_16x16x32_bf16 v[240:243], v[100:103], v[192:195], v[240:243]
    v_mfma_f32_16x16x32_bf16 v[244:247], v[116:119], v[192:195], v[244:247]
    v_mfma_f32_16x16x32_bf16 v[228:231], v[36:39], v[196:199], v[228:231]
    ds_write_b128 v22, v[220:223] offset:1024
    v_mfma_f32_16x16x32_bf16 v[232:235], v[52:55], v[196:199], v[232:235]
    v_mfma_f32_16x16x32_bf16 v[236:239], v[68:71], v[196:199], v[236:239]
    v_mfma_f32_16x16x32_bf16 v[240:243], v[84:87], v[196:199], v[240:243]
    v_mfma_f32_16x16x32_bf16 v[244:247], v[100:103], v[196:199], v[244:247]
    v_mfma_f32_16x16x32_bf16 v[232:235], v[36:39], v[200:203], v[232:235]
    ds_write_b128 v22, v[224:227] offset:2048
    v_mfma_f32_16x16x32_bf16 v[236:239], v[52:55], v[200:203], v[236:239]
    v_mfma_f32_16x16x32_bf16 v[240:243], v[68:71], v[200:203], v[240:243]
    v_mfma_f32_16x16x32_bf16 v[244:247], v[84:87], v[200:203], v[244:247]
    v_mfma_f32_16x16x32_bf16 v[236:239], v[36:39], v[204:207], v[236:239]
    ds_write_b128 v22, v[228:231] offset:3072
    v_mfma_f32_16x16x32_bf16 v[240:243], v[52:55], v[204:207], v[240:243]
    v_mfma_f32_16x16x32_bf16 v[244:247], v[68:71], v[204:207], v[244:247]
    v_mfma_f32_16x16x32_bf16 v[240:243], v[36:39], v[208:211], v[240:243]
    v_mfma_f32_16x16x32_bf16 v[244:247], v[52:55], v[208:211], v[244:247]
    v_mfma_f32_16x16x32_bf16 v[244:247], v[36:39], v[212:215], v[244:247]
    ds_write_b128 v22, v[232:235] offset:4096
    s_nop 1
    ds_write_b128 v22, v[236:239] offset:5120
    s_nop 1
    ds_write_b128 v22, v[240:243] offset:6144
    s_nop 1
    ds_write_b128 v22, v[244:247] offset:7168
    s_waitcnt lgkmcnt(0)
    s_setprio 0
    s_barrier
L_p2:
    s_and_b32 s56, s2, 7
    s_lshr_b32 s57, s2, 3
    s_and_b32 s58, s56, 3
    s_lshl_b32 s58, s58, 2
    s_and_b32 s59, s57, 3
    s_add_u32 s58, s58, s59
    s_lshr_b32 s56, s56, 2
    s_mul_i32 s56, s56, 7
    s_lshr_b32 s59, s57, 2
    s_add_u32 s59, s59, s56
    v_lshrrev_b32 v3, 4, v0
    v_bfe_u32 v13, v0, 1, 3
    v_xor_b32 v13, v13, v3
    v_and_b32 v13, 7, v13
    v_lshlrev_b32 v13, 5, v13
    v_and_b32 v15, 1, v0
    v_lshl_add_u32 v13, v15, 4, v13
    v_mul_u32_u24 v3, 3584, v3
    s_lshl_b32 s62, s59, 8
    v_add3_u32 v13, v13, v3, s62
    v_and_b32 v2, 63, v0
    s_mov_b32 s60, s88
    s_lshl_b32 s61, s58, 17
    s_add_u32 s61, s61, 5242880
    s_add_u32 s32, s28, s61
    s_addc_u32 s33, s29, 0
    s_mov_b32 s34, 131072
    s_mov_b32 s35, 0x00020000
    s_mov_b32 s36, s18
    s_mov_b32 s37, s19
    s_mov_b32 s38, 1835008
    s_mov_b32 s39, 0x00020000
    s_mov_b32 s40, s20
    s_mov_b32 s41, s21
    s_mov_b32 s42, 1835008
    s_mov_b32 s43, 0x00020000
    v_lshlrev_b32 v12, 4, v0
    s_lshl_b32 s63, s60, 10
    s_mov_b32 s64, 0
    s_mov_b32 s65, 688128
    s_add_u32 s44, s28, 8388608
    s_addc_u32 s45, s29, 0
    s_mov_b32 s46, 24117248
    s_mov_b32 s47, 0x00020000
    s_add_u32 s48, s28, 4259840
    s_addc_u32 s49, s29, 0
    s_mov_b32 s50, 24576
    s_mov_b32 s51, 0x00020000
    s_mov_b32 s52, s22
    s_mov_b32 s53, s23
    s_mov_b32 s54, 1835008
    s_mov_b32 s55, 0x00020000
    s_and_b32 s66, s60, 1
    s_lshr_b32 s67, s60, 1
    v_lshrrev_b32 v3, 2, v2
    v_and_b32 v15, 7, v3
    v_lshlrev_b32 v15, 5, v15
    v_lshl_add_u32 v15, v3, 8, v15
    v_and_b32 v3, 3, v2
    v_lshl_add_u32 v15, v3, 3, v15
    s_lshl_b32 s68, s66, 2
    s_add_u32 s68, s68, s67
    s_lshl_b32 s69, s68, 5
    v_xor_b32 v4, s69, v15
    v_add_u32 v4, 98304, v4
    v_xor_b32 v5, 32, v4
    v_xor_b32 v6, 64, v4
    v_xor_b32 v7, 0x60, v4
    s_lshl_b32 s69, s67, 6
    v_xor_b32 v15, s69, v15
    v_add_u32 v8, 0, v15
    v_xor_b32 v9, 32, v8
    v_add_u32 v10, 49152, v15
    v_xor_b32 v11, 32, v10
    v_lshlrev_b32 v14, 4, v2
    s_mov_b32 s70, 0xffff0000
    s_lshl_b32 s71, s59, 9
    s_lshl_b32 s72, s67, 7
    s_add_u32 s71, s71, s72
    s_add_u32 s72, s71, 7168
    s_lshl_b32 s73, s57, 16
    s_lshl_b32 s74, s58, 3
    s_lshl_b32 s75, s59, 2
    s_add_u32 s75, s75, s67
    s_xor_b32 s76, s68, 0
    s_add_u32 s76, s76, s74
    s_mul_i32 s76, s76, 56
    s_add_u32 s76, s76, s75
    s_lshl_b32 s80, s76, 10
    s_xor_b32 s76, s68, 1
    s_add_u32 s76, s76, s74
    s_mul_i32 s76, s76, 56
    s_add_u32 s76, s76, s75
    s_lshl_b32 s81, s76, 10
    s_xor_b32 s76, s68, 2
    s_add_u32 s76, s76, s74
    s_mul_i32 s76, s76, 56
    s_add_u32 s76, s76, s75
    s_lshl_b32 s82, s76, 10
    s_xor_b32 s76, s68, 3
    s_add_u32 s76, s76, s74
    s_mul_i32 s76, s76, 56
    s_add_u32 s76, s76, s75
    s_lshl_b32 s83, s76, 10
    s_sub_u32 s76, s58, s59
    s_add_u32 s76, s76, 32
    s_mul_i32 s76, s76, 128
    s_mul_i32 s73, s59, 128
    v_and_b32 v16, 1, v2
    v_mul_lo_u32 v16, v16, s76
    v_and_b32 v17, 0x30, v2
    v_and_b32 v18, 15, v2
    s_lshl_b32 s76, s68, 4
    v_add_lshl_u32 v18, v18, s76, 2
    s_lshl_b32 s69, s58, 9
    s_add_u32 s69, s69, 16384
    s_lshl_b32 s79, s58, 4
    s_add_u32 s79, s79, s59
    s_mov_b32 s77, 0xc0135761
    s_mov_b32 s78, 0xbdd2d3e8
    s_mul_i32 s99, s75, 4682
    s_lshr_b32 s99, s99, 16
    s_and_b32 s98, s68, 1
    s_lshl1_add_u32 s98, s99, s98
    s_lshl_b32 s98, s98, 7
    s_add_u32 s98, s98, 16776832
    v_lshrrev_b32 v3, 3, v2
    v_cmp_eq_u32 vcc, 3, v3
    v_add_u32 v253, s98, v14
    v_xor_b32 v254, 0x80, v253
    v_cndmask_b32 v253, v14, v253, vcc
    v_cndmask_b32 v254, v14, v254, vcc
    v_lshrrev_b32 v3, 3, v2
    v_bfe_u32 v248, v2, 1, 2
    v_lshrrev_b32 v249, 4, v2
    v_xor_b32 v248, v248, v249
    v_lshlrev_b32 v248, 5, v248
    v_and_b32 v249, 1, v2
    v_lshl_add_u32 v248, v249, 4, v248
    v_lshl_add_u32 v248, v3, 10, v248
    v_add_u32 v249, 7168, v248
    s_mul_i32 s30, s67, 458752
    s_lshl_b32 s3, s66, 14
    s_add_u32 s30, s30, s3
    s_lshr_b32 s3, s2, 5
    s_lshr_b32 s98, s22, 7
    s_sub_u32 s3, s3, s98
    s_add_u32 s3, s3, 4
    s_and_b32 s3, s3, 7
    s_lshl_b32 s3, s3, 7
    s_add_u32 s30, s30, s3
    s_lshl_b32 s3, s88, 11
    s_lshr_b32 s31, s88, 2
    s_mul_i32 s31, s31, 40960
    s_add_u32 s31, s31, s3
    s_add_u32 s3, s3, 98304
    v_lshrrev_b32 v3, 2, v2
    v_bfe_u32 v176, v2, 3, 2
    s_and_b32 s76, s88, 2
    v_xor_b32 v176, s76, v176
    v_lshlrev_b32 v176, 5, v176
    v_lshl_add_u32 v176, v3, 7, v176
    v_and_b32 v3, 3, v2
    v_lshl_add_u32 v176, v3, 3, v176
    s_and_b32 s76, s31, 0xfffff000
    v_add_u32 v168, s76, v176
    s_and_b32 s76, s3, 0xfffff000
    v_add_u32 v172, s76, v176
    v_xor_b32 v169, 32, v168
    v_xor_b32 v173, 32, v172
    v_xor_b32 v170, 64, v168
    v_xor_b32 v174, 64, v172
    v_xor_b32 v171, 96, v168
    v_xor_b32 v175, 96, v172
    s_add_u32 s30, s30, 65536
    s_barrier
    s_cmp_ge_u32 s88, 4
    s_cbranch_scc1 L_hw_17
    s_cmp_ge_u32 s57, 28
    s_cbranch_scc1 L_nopoll_16
    s_add_u32 m0, s3, 16384
    s_add_u32 s76, s30, 4294901760
    buffer_load_dwordx4 v248, s[52:55], s76 offen lds
    buffer_load_dwordx4 v249, s[52:55], s76 offen offset:1024 lds
    s_add_u32 m0, s3, 24576
    s_add_u32 s76, s30, 851968
    buffer_load_dwordx4 v248, s[52:55], s76 offen lds
    buffer_load_dwordx4 v249, s[52:55], s76 offen offset:1024 lds
    s_add_u32 m0, s3, 32768
    s_add_u32 s76, s30, 4294934528
    buffer_load_dwordx4 v248, s[52:55], s76 offen lds
    buffer_load_dwordx4 v249, s[52:55], s76 offen offset:1024 lds
    s_add_u32 m0, s3, 40960
    s_add_u32 s76, s30, 884736
    buffer_load_dwordx4 v248, s[52:55], s76 offen lds
    buffer_load_dwordx4 v249, s[52:55], s76 offen offset:1024 lds
    s_waitcnt vmcnt(0)
    s_branch L_nopoll_16
L_hw_17:
    s_mul_i32 s90, s2, 128
    s_add_u32 s90, s90, 16
    s_lshl_b32 s91, s2, 2
    s_add_u32 s91, s91, 33792
    v_mov_b32 v250, -1
    v_writelane_b32 v250, s90, 0
    v_writelane_b32 v250, s91, 1
    s_and_b32 s90, s2, 7
    s_mul_i32 s90, s90, 4096
    v_and_b32 v243, 31, v0
    v_mul_u32_u24 v243, 128, v243
    v_add_u32 v243, s90, v243
    v_mov_b32 v244, 147460
    v_mov_b32 v251, 1
    s_mov_b64 exec, 1
    s_waitcnt vmcnt(0)
    ds_add_rtn_u32 v251, v244, v251
    s_mov_b64 exec, -1
    s_waitcnt lgkmcnt(0)
    v_readfirstlane_b32 s90, v251
    s_cmp_lg_u32 s90, 3
    s_cbranch_scc1 L_nopoll_16
    v_mov_b32 v251, s100
    buffer_store_dword v251, v250, s[84:87], 0 offen sc1
    s_cmp_ge_u32 s57, 30
    s_cbranch_scc1 L_nopoll_16
L_poll_18:
    buffer_load_dword v251, v243, s[84:87], 0 offen offset:16 sc1
    s_sub_u32 s89, s89, 1
    s_cbranch_scc1 L_pollx_19
L_polly_20:
    s_waitcnt vmcnt(0)
    v_cmp_ne_u32 vcc, s100, v251
    s_cbranch_vccnz L_poll_18
L_pollx_19:
    s_max_i32 s89, s89, 0
    s_mov_b32 s91, 33792
L_poll_21:
    buffer_load_dwordx4 v[244:247], v14, s[84:87], s91 offen sc1
    s_sub_u32 s89, s89, 1
    s_cbranch_scc1 L_pollx_22
L_polly_23:
    s_waitcnt vmcnt(0)
    v_xor_b32 v244, s100, v244
    v_xor_b32 v245, s100, v245
    v_xor_b32 v246, s100, v246
    v_xor_b32 v247, s100, v247
    v_or_b32 v244, v244, v245
    v_or3_b32 v244, v244, v246, v247
    v_cmp_ne_u32 vcc, 0, v244
    s_cbranch_vccnz L_poll_21
L_pollx_22:
    s_max_i32 s89, s89, 0
    s_cmp_lg_u32 s2, 0
    s_cbranch_scc1 L_nopoll_16
    v_mov_b32 v251, s100
    s_mul_i32 s90, 0, 128
    s_mov_b64 exec, 1
    buffer_store_dword v251, off, s[84:87], s90 offset:48 sc1
    s_mov_b64 exec, -1
L_nopoll_16:
    s_barrier
    s_cmp_ge_u32 s57, 28
    s_cbranch_scc1 L_spare
    s_add_u32 m0, s63, 98304
    s_nop 0
    buffer_load_dwordx4 v12, s[32:35], s64 offen sc1 lds
    s_add_u32 s64, s64, 8192
    s_add_u32 m0, s63, 106496
    s_nop 0
    buffer_load_dwordx4 v12, s[32:35], s64 offen sc1 lds
    s_add_u32 s64, s64, 8192
    ds_read_b64_tr_b16 v[216:217], v172 offset:16384
    ds_read_b64_tr_b16 v[218:219], v172 offset:18432
    ds_read_b64_tr_b16 v[220:221], v173 offset:16384
    ds_read_b64_tr_b16 v[222:223], v173 offset:18432
    ds_read_b64_tr_b16 v[224:225], v174 offset:16384
    ds_read_b64_tr_b16 v[226:227], v174 offset:18432
    ds_read_b64_tr_b16 v[228:229], v175 offset:16384
    ds_read_b64_tr_b16 v[230:231], v175 offset:18432
    ds_read_b64_tr_b16 v[232:233], v172 offset:32768
    ds_read_b64_tr_b16 v[234:235], v172 offset:34816
    ds_read_b64_tr_b16 v[236:237], v173 offset:32768
    ds_read_b64_tr_b16 v[238:239], v173 offset:34816
    ds_read_b64_tr_b16 v[240:241], v174 offset:32768
    ds_read_b64_tr_b16 v[242:243], v174 offset:34816
    ds_read_b64_tr_b16 v[244:245], v175 offset:32768
    ds_read_b64_tr_b16 v[246:247], v175 offset:34816
    s_waitcnt lgkmcnt(0)
    s_barrier
    s_add_u32 m0, s63, 114688
    s_nop 0
    buffer_load_dwordx4 v12, s[32:35], s64 offen sc1 lds
    s_add_u32 s64, s64, 8192
    s_add_u32 m0, s63, 122880
    s_nop 0
    buffer_load_dwordx4 v12, s[32:35], s64 offen sc1 lds
    s_add_u32 s64, s64, 8192
    s_add_u32 m0, s63, 131072
    s_nop 0
    buffer_load_dwordx4 v12, s[32:35], s64 offen sc1 lds
    s_add_u32 s64, s64, 8192
    s_add_u32 m0, s63, 139264
    s_nop 0
    buffer_load_dwordx4 v12, s[32:35], s64 offen sc1 lds
    s_add_u32 s64, s64, 8192
    s_waitcnt vmcnt(5)
    s_barrier
    ds_read_b64_tr_b16 v[40:41], v8 offset:0
    ds_read_b64_tr_b16 v[42:43], v8 offset:4096
    ds_read_b64_tr_b16 v[56:57], v4 offset:0
    ds_read_b64_tr_b16 v[58:59], v4 offset:4096
    ds_read_b64_tr_b16 v[44:45], v9 offset:0
    ds_read_b64_tr_b16 v[46:47], v9 offset:4096
    ds_read_b64_tr_b16 v[60:61], v5 offset:0
    ds_read_b64_tr_b16 v[62:63], v5 offset:4096
    ds_read_b64_tr_b16 v[48:49], v10 offset:0
    ds_read_b64_tr_b16 v[50:51], v10 offset:4096
    ds_read_b64_tr_b16 v[64:65], v6 offset:0
    ds_read_b64_tr_b16 v[66:67], v6 offset:4096
    ds_read_b64_tr_b16 v[52:53], v11 offset:0
    ds_read_b64_tr_b16 v[54:55], v11 offset:4096
    ds_read_b64_tr_b16 v[68:69], v7 offset:0
    ds_read_b64_tr_b16 v[70:71], v7 offset:4096
    s_waitcnt vmcnt(4)
    s_barrier
    s_waitcnt lgkmcnt(12)
    v_mfma_f32_16x16x32_bf16 v[104:107], v[40:43], v[56:59], 0
    ds_read_b64_tr_b16 v[72:73], v8 offset:8192
    s_waitcnt lgkmcnt(11)
    v_mfma_f32_16x16x32_bf16 v[108:111], v[44:47], v[56:59], 0
    ds_read_b64_tr_b16 v[74:75], v8 offset:12288
    s_waitcnt lgkmcnt(10)
    v_mfma_f32_16x16x32_bf16 v[120:123], v[40:43], v[60:63], 0
    ds_read_b64_tr_b16 v[88:89], v4 offset:8192
    v_mfma_f32_16x16x32_bf16 v[124:127], v[44:47], v[60:63], 0
    ds_read_b64_tr_b16 v[90:91], v4 offset:12288
    s_waitcnt vmcnt(3) lgkmcnt(4)
    s_barrier
    v_mfma_f32_16x16x32_bf16 v[112:115], v[48:51], v[56:59], 0
    ds_read_b64_tr_b16 v[76:77], v9 offset:8192
    s_add_u32 m0, s63, 0
    s_nop 0
    buffer_load_dwordx4 v13, s[36:39], s65 offen lds
    v_mfma_f32_16x16x32_bf16 v[128:131], v[48:51], v[60:63], 0
    ds_read_b64_tr_b16 v[78:79], v9 offset:12288
    v_mfma_f32_16x16x32_bf16 v[136:139], v[40:43], v[64:67], 0
    ds_read_b64_tr_b16 v[92:93], v5 offset:8192
    s_add_u32 m0, s63, 49152
    s_nop 0
    buffer_load_dwordx4 v13, s[40:43], s65 offen lds
    v_mfma_f32_16x16x32_bf16 v[140:143], v[44:47], v[64:67], 0
    ds_read_b64_tr_b16 v[94:95], v5 offset:12288
    v_mfma_f32_16x16x32_bf16 v[144:147], v[48:51], v[64:67], 0
    ds_read_b64_tr_b16 v[80:81], v10 offset:8192
    s_add_u32 m0, s63, 98304
    s_add_u32 s65, s65, 114688
    buffer_load_dwordx4 v12, s[32:35], s64 offen sc1 lds
    s_add_u32 s64, s64, 8192
    v_mfma_f32_16x16x32_bf16 v[116:119], v[52:55], v[56:59], 0
    ds_read_b64_tr_b16 v[82:83], v10 offset:12288
    v_mfma_f32_16x16x32_bf16 v[132:135], v[52:55], v[60:63], 0
    ds_read_b64_tr_b16 v[96:97], v6 offset:8192
    v_mfma_f32_16x16x32_bf16 v[148:151], v[52:55], v[64:67], 0
    ds_read_b64_tr_b16 v[98:99], v6 offset:12288
    v_mfma_f32_16x16x32_bf16 v[152:155], v[40:43], v[68:71], 0
    ds_read_b64_tr_b16 v[84:85], v11 offset:8192
    v_mfma_f32_16x16x32_bf16 v[156:159], v[44:47], v[68:71], 0
    ds_read_b64_tr_b16 v[86:87], v11 offset:12288
    v_mfma_f32_16x16x32_bf16 v[160:163], v[48:51], v[68:71], 0
    ds_read_b64_tr_b16 v[100:101], v7 offset:8192
    v_mfma_f32_16x16x32_bf16 v[164:167], v[52:55], v[68:71], 0
    ds_read_b64_tr_b16 v[102:103], v7 offset:12288
    s_waitcnt lgkmcnt(12)
    v_mfma_f32_16x16x32_bf16 v[104:107], v[72:75], v[88:91], v[104:107]
    ds_read_b64_tr_b16 v[40:41], v8 offset:16384
    s_waitcnt lgkmcnt(11)
    v_mfma_f32_16x16x32_bf16 v[108:111], v[76:79], v[88:91], v[108:111]
    ds_read_b64_tr_b16 v[42:43], v8 offset:20480
    s_waitcnt lgkmcnt(10)
    v_mfma_f32_16x16x32_bf16 v[120:123], v[72:75], v[92:95], v[120:123]
    ds_read_b64_tr_b16 v[56:57], v4 offset:16384
    v_mfma_f32_16x16x32_bf16 v[124:127], v[76:79], v[92:95], v[124:127]
    ds_read_b64_tr_b16 v[58:59], v4 offset:20480
    s_waitcnt vmcnt(5) lgkmcnt(4)
    s_barrier
    v_mfma_f32_16x16x32_bf16 v[112:115], v[80:83], v[88:91], v[112:115]
    ds_read_b64_tr_b16 v[44:45], v9 offset:16384
    s_add_u32 m0, s63, 8192
    s_nop 0
    buffer_load_dwordx4 v13, s[36:39], s65 offen lds
    v_mfma_f32_16x16x32_bf16 v[128:131], v[80:83], v[92:95], v[128:131]
    ds_read_b64_tr_b16 v[46:47], v9 offset:20480
    v_mfma_f32_16x16x32_bf16 v[136:139], v[72:75], v[96:99], v[136:139]
    ds_read_b64_tr_b16 v[60:61], v5 offset:16384
    s_add_u32 m0, s63, 57344
    s_nop 0
    buffer_load_dwordx4 v13, s[40:43], s65 offen lds
    v_mfma_f32_16x16x32_bf16 v[140:143], v[76:79], v[96:99], v[140:143]
    ds_read_b64_tr_b16 v[62:63], v5 offset:20480
    v_mfma_f32_16x16x32_bf16 v[144:147], v[80:83], v[96:99], v[144:147]
    ds_read_b64_tr_b16 v[48:49], v10 offset:16384
    s_add_u32 m0, s63, 106496
    s_add_u32 s65, s65, 114688
    buffer_load_dwordx4 v12, s[32:35], s64 offen sc1 lds
    s_add_u32 s64, s64, 8192
    v_mfma_f32_16x16x32_bf16 v[116:119], v[84:87], v[88:91], v[116:119]
    ds_read_b64_tr_b16 v[50:51], v10 offset:20480
    v_mfma_f32_16x16x32_bf16 v[132:135], v[84:87], v[92:95], v[132:135]
    ds_read_b64_tr_b16 v[64:65], v6 offset:16384
    v_mfma_f32_16x16x32_bf16 v[148:151], v[84:87], v[96:99], v[148:151]
    ds_read_b64_tr_b16 v[66:67], v6 offset:20480
    v_mfma_f32_16x16x32_bf16 v[152:155], v[72:75], v[100:103], v[152:155]
    ds_read_b64_tr_b16 v[52:53], v11 offset:16384
    v_mfma_f32_16x16x32_bf16 v[156:159], v[76:79], v[100:103], v[156:159]
    ds_read_b64_tr_b16 v[54:55], v11 offset:20480
    v_mfma_f32_16x16x32_bf16 v[160:163], v[80:83], v[100:103], v[160:163]
    ds_read_b64_tr_b16 v[68:69], v7 offset:16384
    v_mfma_f32_16x16x32_bf16 v[164:167], v[84:87], v[100:103], v[164:167]
    ds_read_b64_tr_b16 v[70:71], v7 offset:20480
    s_waitcnt lgkmcnt(12)
    v_mfma_f32_16x16x32_bf16 v[104:107], v[40:43], v[56:59], v[104:107]
    ds_read_b64_tr_b16 v[72:73], v8 offset:24576
    s_waitcnt lgkmcnt(11)
    v_mfma_f32_16x16x32_bf16 v[108:111], v[44:47], v[56:59], v[108:111]
    ds_read_b64_tr_b16 v[74:75], v8 offset:28672
    s_waitcnt lgkmcnt(10)
    v_mfma_f32_16x16x32_bf16 v[120:123], v[40:43], v[60:63], v[120:123]
    ds_read_b64_tr_b16 v[88:89], v4 offset:24576
    v_mfma_f32_16x16x32_bf16 v[124:127], v[44:47], v[60:63], v[124:127]
    ds_read_b64_tr_b16 v[90:91], v4 offset:28672
    s_waitcnt vmcnt(7) lgkmcnt(4)
    s_barrier
    v_mfma_f32_16x16x32_bf16 v[112:115], v[48:51], v[56:59], v[112:115]
    ds_read_b64_tr_b16 v[76:77], v9 offset:24576
    s_add_u32 m0, s3, 49152
    s_nop 0
    buffer_load_dwordx4 v248, s[52:55], s30 offen lds
    v_mfma_f32_16x16x32_bf16 v[128:131], v[48:51], v[60:63], v[128:131]
    ds_read_b64_tr_b16 v[78:79], v9 offset:28672
    v_mfma_f32_16x16x32_bf16 v[136:139], v[40:43], v[64:67], v[136:139]
    ds_read_b64_tr_b16 v[92:93], v5 offset:24576
    buffer_load_dwordx4 v249, s[52:55], s30 offen offset:1024 lds
    s_add_u32 s30, s30, 32768
    v_mfma_f32_16x16x32_bf16 v[140:143], v[44:47], v[64:67], v[140:143]
    ds_read_b64_tr_b16 v[94:95], v5 offset:28672
    v_mfma_f32_16x16x32_bf16 v[144:147], v[48:51], v[64:67], v[144:147]
    ds_read_b64_tr_b16 v[80:81], v10 offset:24576
    s_add_u32 m0, s63, 16384
    s_nop 0
    buffer_load_dwordx4 v13, s[36:39], s65 offen lds
    v_mfma_f32_16x16x32_bf16 v[116:119], v[52:55], v[56:59], v[116:119]
    ds_read_b64_tr_b16 v[82:83], v10 offset:28672
    v_mfma_f32_16x16x32_bf16 v[132:135], v[52:55], v[60:63], v[132:135]
    ds_read_b64_tr_b16 v[96:97], v6 offset:24576
    s_add_u32 m0, s63, 65536
    s_nop 0
    buffer_load_dwordx4 v13, s[40:43], s65 offen lds
    v_mfma_f32_16x16x32_bf16 v[148:151], v[52:55], v[64:67], v[148:151]
    ds_read_b64_tr_b16 v[98:99], v6 offset:28672
    v_mfma_f32_16x16x32_bf16 v[152:155], v[40:43], v[68:71], v[152:155]
    ds_read_b64_tr_b16 v[84:85], v11 offset:24576
    s_add_u32 m0, s63, 114688
    s_add_u32 s65, s65, 114688
    buffer_load_dwordx4 v12, s[32:35], s64 offen sc1 lds
    s_add_u32 s64, s64, 8192
    v_mfma_f32_16x16x32_bf16 v[156:159], v[44:47], v[68:71], v[156:159]
    ds_read_b64_tr_b16 v[86:87], v11 offset:28672
    v_mfma_f32_16x16x32_bf16 v[160:163], v[48:51], v[68:71], v[160:163]
    ds_read_b64_tr_b16 v[100:101], v7 offset:24576
    v_mfma_f32_16x16x32_bf16 v[164:167], v[52:55], v[68:71], v[164:167]
    ds_read_b64_tr_b16 v[102:103], v7 offset:28672
    s_waitcnt lgkmcnt(12)
    v_mfma_f32_16x16x32_bf16 v[104:107], v[72:75], v[88:91], v[104:107]
    ds_read_b64_tr_b16 v[40:41], v8 offset:32768
    s_waitcnt lgkmcnt(11)
    v_mfma_f32_16x16x32_bf16 v[108:111], v[76:79], v[88:91], v[108:111]
    ds_read_b64_tr_b16 v[42:43], v8 offset:36864
    s_waitcnt lgkmcnt(10)
    v_mfma_f32_16x16x32_bf16 v[120:123], v[72:75], v[92:95], v[120:123]
    ds_read_b64_tr_b16 v[56:57], v4 offset:32768
    v_mfma_f32_16x16x32_bf16 v[124:127], v[76:79], v[92:95], v[124:127]
    ds_read_b64_tr_b16 v[58:59], v4 offset:36864
    s_waitcnt vmcnt(11) lgkmcnt(4)
    s_barrier
    v_mfma_f32_16x16x32_bf16 v[112:115], v[80:83], v[88:91], v[112:115]
    ds_read_b64_tr_b16 v[44:45], v9 offset:32768
    s_add_u32 m0, s63, 24576
    s_nop 0
    buffer_load_dwordx4 v13, s[36:39], s65 offen lds
    v_mfma_f32_16x16x32_bf16 v[128:131], v[80:83], v[92:95], v[128:131]
    ds_read_b64_tr_b16 v[46:47], v9 offset:36864
    v_mfma_f32_16x16x32_bf16 v[136:139], v[72:75], v[96:99], v[136:139]
    ds_read_b64_tr_b16 v[60:61], v5 offset:32768
    s_add_u32 m0, s63, 73728
    s_nop 0
    buffer_load_dwordx4 v13, s[40:43], s65 offen lds
    v_mfma_f32_16x16x32_bf16 v[140:143], v[76:79], v[96:99], v[140:143]
    ds_read_b64_tr_b16 v[62:63], v5 offset:36864
    v_mfma_f32_16x16x32_bf16 v[144:147], v[80:83], v[96:99], v[144:147]
    ds_read_b64_tr_b16 v[48:49], v10 offset:32768
    s_add_u32 m0, s63, 122880
    s_add_u32 s65, s65, 114688
    buffer_load_dwordx4 v12, s[32:35], s64 offen sc1 lds
    s_add_u32 s64, s64, 8192
    v_mfma_f32_16x16x32_bf16 v[116:119], v[84:87], v[88:91], v[116:119]
    ds_read_b64_tr_b16 v[50:51], v10 offset:36864
    v_mfma_f32_16x16x32_bf16 v[132:135], v[84:87], v[92:95], v[132:135]
    ds_read_b64_tr_b16 v[64:65], v6 offset:32768
    v_mfma_f32_16x16x32_bf16 v[148:151], v[84:87], v[96:99], v[148:151]
    ds_read_b64_tr_b16 v[66:67], v6 offset:36864
    v_mfma_f32_16x16x32_bf16 v[152:155], v[72:75], v[100:103], v[152:155]
    ds_read_b64_tr_b16 v[52:53], v11 offset:32768
    v_mfma_f32_16x16x32_bf16 v[156:159], v[76:79], v[100:103], v[156:159]
    ds_read_b64_tr_b16 v[54:55], v11 offset:36864
    v_mfma_f32_16x16x32_bf16 v[160:163], v[80:83], v[100:103], v[160:163]
    ds_read_b64_tr_b16 v[68:69], v7 offset:32768
    v_mfma_f32_16x16x32_bf16 v[164:167], v[84:87], v[100:103], v[164:167]
    ds_read_b64_tr_b16 v[70:71], v7 offset:36864
    s_waitcnt lgkmcnt(12)
    v_mfma_f32_16x16x32_bf16 v[104:107], v[40:43], v[56:59], v[104:107]
    ds_read_b64_tr_b16 v[72:73], v8 offset:40960
    s_waitcnt lgkmcnt(11)
    v_mfma_f32_16x16x32_bf16 v[108:111], v[44:47], v[56:59], v[108:111]
    ds_read_b64_tr_b16 v[74:75], v8 offset:45056
    s_waitcnt lgkmcnt(10)
    v_mfma_f32_16x16x32_bf16 v[120:123], v[40:43], v[60:63], v[120:123]
    ds_read_b64_tr_b16 v[88:89], v4 offset:40960
    v_mfma_f32_16x16x32_bf16 v[124:127], v[44:47], v[60:63], v[124:127]
    ds_read_b64_tr_b16 v[90:91], v4 offset:45056
    s_waitcnt vmcnt(11) lgkmcnt(4)
    s_barrier
    v_mfma_f32_16x16x32_bf16 v[112:115], v[48:51], v[56:59], v[112:115]
    ds_read_b64_tr_b16 v[76:77], v9 offset:40960
    s_add_u32 m0, s63, 32768
    s_nop 0
    buffer_load_dwordx4 v13, s[36:39], s65 offen lds
    v_mfma_f32_16x16x32_bf16 v[128:131], v[48:51], v[60:63], v[128:131]
    ds_read_b64_tr_b16 v[78:79], v9 offset:45056
    v_mfma_f32_16x16x32_bf16 v[136:139], v[40:43], v[64:67], v[136:139]
    ds_read_b64_tr_b16 v[92:93], v5 offset:40960
    s_add_u32 m0, s63, 81920
    s_nop 0
    buffer_load_dwordx4 v13, s[40:43], s65 offen lds
    v_mfma_f32_16x16x32_bf16 v[140:143], v[44:47], v[64:67], v[140:143]
    ds_read_b64_tr_b16 v[94:95], v5 offset:45056
    v_mfma_f32_16x16x32_bf16 v[144:147], v[48:51], v[64:67], v[144:147]
    ds_read_b64_tr_b16 v[80:81], v10 offset:40960
    s_add_u32 m0, s63, 131072
    s_add_u32 s65, s65, 114688
    buffer_load_dwordx4 v12, s[32:35], s64 offen sc1 lds
    s_add_u32 s64, s64, 8192
    v_mfma_f32_16x16x32_bf16 v[116:119], v[52:55], v[56:59], v[116:119]
    ds_read_b64_tr_b16 v[82:83], v10 offset:45056
    v_mfma_f32_16x16x32_bf16 v[132:135], v[52:55], v[60:63], v[132:135]
    ds_read_b64_tr_b16 v[96:97], v6 offset:40960
    v_mfma_f32_16x16x32_bf16 v[148:151], v[52:55], v[64:67], v[148:151]
    ds_read_b64_tr_b16 v[98:99], v6 offset:45056
    v_mfma_f32_16x16x32_bf16 v[152:155], v[40:43], v[68:71], v[152:155]
    ds_read_b64_tr_b16 v[84:85], v11 offset:40960
    v_mfma_f32_16x16x32_bf16 v[156:159], v[44:47], v[68:71], v[156:159]
    ds_read_b64_tr_b16 v[86:87], v11 offset:45056
    v_mfma_f32_16x16x32_bf16 v[160:163], v[48:51], v[68:71], v[160:163]
    ds_read_b64_tr_b16 v[100:101], v7 offset:40960
    v_mfma_f32_16x16x32_bf16 v[164:167], v[52:55], v[68:71], v[164:167]
    ds_read_b64_tr_b16 v[102:103], v7 offset:45056
    s_waitcnt lgkmcnt(12)
    v_mfma_f32_16x16x32_bf16 v[104:107], v[72:75], v[88:91], v[104:107]
    ds_read_b64_tr_b16 v[40:41], v8 offset:0
    s_waitcnt lgkmcnt(11)
    v_mfma_f32_16x16x32_bf16 v[108:111], v[76:79], v[88:91], v[108:111]
    ds_read_b64_tr_b16 v[42:43], v8 offset:4096
    s_waitcnt lgkmcnt(10)
    v_mfma_f32_16x16x32_bf16 v[120:123], v[72:75], v[92:95], v[120:123]
    ds_read_b64_tr_b16 v[56:57], v4 offset:0
    v_mfma_f32_16x16x32_bf16 v[124:127], v[76:79], v[92:95], v[124:127]
    ds_read_b64_tr_b16 v[58:59], v4 offset:4096
    s_waitcnt vmcnt(9) lgkmcnt(4)
    s_barrier
    v_mfma_f32_16x16x32_bf16 v[112:115], v[80:83], v[88:91], v[112:115]
    ds_read_b64_tr_b16 v[44:45], v9 offset:0
    ds_read_b64_tr_b16 v[200:201], v172 offset:49152
    s_add_u32 m0, s63, 40960
    s_nop 0
    buffer_load_dwordx4 v13, s[36:39], s65 offen lds
    v_mfma_f32_16x16x32_bf16 v[128:131], v[80:83], v[92:95], v[128:131]
    ds_read_b64_tr_b16 v[46:47], v9 offset:4096
    ds_read_b64_tr_b16 v[202:203], v172 offset:51200
    v_mfma_f32_16x16x32_bf16 v[136:139], v[72:75], v[96:99], v[136:139]
    ds_read_b64_tr_b16 v[60:61], v5 offset:0
    ds_read_b64_tr_b16 v[204:205], v173 offset:49152
    s_add_u32 m0, s63, 90112
    s_nop 0
    buffer_load_dwordx4 v13, s[40:43], s65 offen lds
    v_mfma_f32_16x16x32_bf16 v[140:143], v[76:79], v[96:99], v[140:143]
    ds_read_b64_tr_b16 v[62:63], v5 offset:4096
    ds_read_b64_tr_b16 v[206:207], v173 offset:51200
    v_mfma_f32_16x16x32_bf16 v[144:147], v[80:83], v[96:99], v[144:147]
    ds_read_b64_tr_b16 v[48:49], v10 offset:0
    ds_read_b64_tr_b16 v[208:209], v174 offset:49152
    s_add_u32 m0, s63, 139264
    s_add_u32 s65, s65, 114688
    buffer_load_dwordx4 v12, s[32:35], s64 offen sc1 lds
    s_add_u32 s64, s64, 8192
    v_mfma_f32_16x16x32_bf16 v[116:119], v[84:87], v[88:91], v[116:119]
    ds_read_b64_tr_b16 v[50:51], v10 offset:4096
    ds_read_b64_tr_b16 v[210:211], v174 offset:51200
    v_mfma_f32_16x16x32_bf16 v[132:135], v[84:87], v[92:95], v[132:135]
    ds_read_b64_tr_b16 v[64:65], v6 offset:0
    ds_read_b64_tr_b16 v[212:213], v175 offset:49152
    v_mfma_f32_16x16x32_bf16 v[148:151], v[84:87], v[96:99], v[148:151]
    ds_read_b64_tr_b16 v[66:67], v6 offset:4096
    ds_read_b64_tr_b16 v[214:215], v175 offset:51200
    v_mfma_f32_16x16x32_bf16 v[152:155], v[72:75], v[100:103], v[152:155]
    ds_read_b64_tr_b16 v[52:53], v11 offset:0
    v_mfma_f32_16x16x32_bf16 v[156:159], v[76:79], v[100:103], v[156:159]
    ds_read_b64_tr_b16 v[54:55], v11 offset:4096
    v_mfma_f32_16x16x32_bf16 v[160:163], v[80:83], v[100:103], v[160:163]
    ds_read_b64_tr_b16 v[68:69], v7 offset:0
    v_mfma_f32_16x16x32_bf16 v[164:167], v[84:87], v[100:103], v[164:167]
    ds_read_b64_tr_b16 v[70:71], v7 offset:4096
    s_waitcnt lgkmcnt(12)
    v_mfma_f32_16x16x32_bf16 v[104:107], v[40:43], v[56:59], v[104:107]
    ds_read_b64_tr_b16 v[72:73], v8 offset:8192
    s_waitcnt lgkmcnt(11)
    v_mfma_f32_16x16x32_bf16 v[108:111], v[44:47], v[56:59], v[108:111]
    ds_read_b64_tr_b16 v[74:75], v8 offset:12288
    s_waitcnt lgkmcnt(10)
    v_mfma_f32_16x16x32_bf16 v[120:123], v[40:43], v[60:63], v[120:123]
    ds_read_b64_tr_b16 v[88:89], v4 offset:8192
    v_mfma_f32_16x16x32_bf16 v[124:127], v[44:47], v[60:63], v[124:127]
    ds_read_b64_tr_b16 v[90:91], v4 offset:12288
    s_waitcnt vmcnt(9) lgkmcnt(4)
    s_barrier
    v_mfma_f32_16x16x32_bf16 v[112:115], v[48:51], v[56:59], v[112:115]
    ds_read_b64_tr_b16 v[76:77], v9 offset:8192
    s_add_u32 m0, s63, 0
    s_nop 0
    buffer_load_dwordx4 v13, s[36:39], s65 offen lds
    v_mfma_f32_16x16x32_bf16 v[128:131], v[48:51], v[60:63], v[128:131]
    ds_read_b64_tr_b16 v[78:79], v9 offset:12288
    v_mfma_f32_16x16x32_bf16 v[136:139], v[40:43], v[64:67], v[136:139]
    ds_read_b64_tr_b16 v[92:93], v5 offset:8192
    s_add_u32 m0, s63, 49152
    s_nop 0
    buffer_load_dwordx4 v13, s[40:43], s65 offen lds
    v_mfma_f32_16x16x32_bf16 v[140:143], v[44:47], v[64:67], v[140:143]
    ds_read_b64_tr_b16 v[94:95], v5 offset:12288
    v_mfma_f32_16x16x32_bf16 v[144:147], v[48:51], v[64:67], v[144:147]
    ds_read_b64_tr_b16 v[80:81], v10 offset:8192
    s_add_u32 m0, s63, 98304
    s_add_u32 s65, s65, 114688
    buffer_load_dwordx4 v12, s[32:35], s64 offen sc1 lds
    s_add_u32 s64, s64, 8192
    v_mfma_f32_16x16x32_bf16 v[116:119], v[52:55], v[56:59], v[116:119]
    ds_read_b64_tr_b16 v[82:83], v10 offset:12288
    v_mfma_f32_16x16x32_bf16 v[132:135], v[52:55], v[60:63], v[132:135]
    ds_read_b64_tr_b16 v[96:97], v6 offset:8192
    v_mfma_f32_16x16x32_bf16 v[148:151], v[52:55], v[64:67], v[148:151]
    ds_read_b64_tr_b16 v[98:99], v6 offset:12288
    v_mfma_f32_16x16x32_bf16 v[152:155], v[40:43], v[68:71], v[152:155]
    ds_read_b64_tr_b16 v[84:85], v11 offset:8192
    v_mfma_f32_16x16x32_bf16 v[156:159], v[44:47], v[68:71], v[156:159]
    ds_read_b64_tr_b16 v[86:87], v11 offset:12288
    v_mfma_f32_16x16x32_bf16 v[160:163], v[48:51], v[68:71], v[160:163]
    ds_read_b64_tr_b16 v[100:101], v7 offset:8192
    v_mfma_f32_16x16x32_bf16 v[164:167], v[52:55], v[68:71], v[164:167]
    ds_read_b64_tr_b16 v[102:103], v7 offset:12288
    s_waitcnt lgkmcnt(12)
    v_mfma_f32_16x16x32_bf16 v[104:107], v[72:75], v[88:91], v[104:107]
    ds_read_b64_tr_b16 v[40:41], v8 offset:16384
    s_waitcnt lgkmcnt(11)
    v_mfma_f32_16x16x32_bf16 v[108:111], v[76:79], v[88:91], v[108:111]
    ds_read_b64_tr_b16 v[42:43], v8 offset:20480
    s_waitcnt lgkmcnt(10)
    v_mfma_f32_16x16x32_bf16 v[120:123], v[72:75], v[92:95], v[120:123]
    ds_read_b64_tr_b16 v[56:57], v4 offset:16384
    v_mfma_f32_16x16x32_bf16 v[124:127], v[76:79], v[92:95], v[124:127]
    ds_read_b64_tr_b16 v[58:59], v4 offset:20480
    s_waitcnt vmcnt(9) lgkmcnt(4)
    s_barrier
    v_mfma_f32_16x16x32_bf16 v[112:115], v[80:83], v[88:91], v[112:115]
    ds_read_b64_tr_b16 v[44:45], v9 offset:16384
    s_add_u32 m0, s63, 8192
    s_nop 0
    buffer_load_dwordx4 v13, s[36:39], s65 offen lds
    v_mfma_f32_16x16x32_bf16 v[128:131], v[80:83], v[92:95], v[128:131]
    ds_read_b64_tr_b16 v[46:47], v9 offset:20480
    v_mfma_f32_16x16x32_bf16 v[136:139], v[72:75], v[96:99], v[136:139]
    ds_read_b64_tr_b16 v[60:61], v5 offset:16384
    s_add_u32 m0, s63, 57344
    s_nop 0
    buffer_load_dwordx4 v13, s[40:43], s65 offen lds
    v_mfma_f32_16x16x32_bf16 v[140:143], v[76:79], v[96:99], v[140:143]
    ds_read_b64_tr_b16 v[62:63], v5 offset:20480
    v_mfma_f32_16x16x32_bf16 v[144:147], v[80:83], v[96:99], v[144:147]
    ds_read_b64_tr_b16 v[48:49], v10 offset:16384
    s_add_u32 m0, s63, 106496
    s_add_u32 s65, s65, 114688
    buffer_load_dwordx4 v12, s[32:35], s64 offen sc1 lds
    s_add_u32 s64, s64, 8192
    v_mfma_f32_16x16x32_bf16 v[116:119], v[84:87], v[88:91], v[116:119]
    ds_read_b64_tr_b16 v[50:51], v10 offset:20480
    v_mfma_f32_16x16x32_bf16 v[132:135], v[84:87], v[92:95], v[132:135]
    ds_read_b64_tr_b16 v[64:65], v6 offset:16384
    v_mfma_f32_16x16x32_bf16 v[148:151], v[84:87], v[96:99], v[148:151]
    ds_read_b64_tr_b16 v[66:67], v6 offset:20480
    v_mfma_f32_16x16x32_bf16 v[152:155], v[72:75], v[100:103], v[152:155]
    ds_read_b64_tr_b16 v[52:53], v11 offset:16384
    v_mfma_f32_16x16x32_bf16 v[156:159], v[76:79], v[100:103], v[156:159]
    ds_read_b64_tr_b16 v[54:55], v11 offset:20480
    v_mfma_f32_16x16x32_bf16 v[160:163], v[80:83], v[100:103], v[160:163]
    ds_read_b64_tr_b16 v[68:69], v7 offset:16384
    v_mfma_f32_16x16x32_bf16 v[164:167], v[84:87], v[100:103], v[164:167]
    ds_read_b64_tr_b16 v[70:71], v7 offset:20480
    s_waitcnt lgkmcnt(12)
    v_mfma_f32_16x16x32_bf16 v[104:107], v[40:43], v[56:59], v[104:107]
    ds_read_b64_tr_b16 v[72:73], v8 offset:24576
    s_waitcnt lgkmcnt(11)
    v_mfma_f32_16x16x32_bf16 v[108:111], v[44:47], v[56:59], v[108:111]
    ds_read_b64_tr_b16 v[74:75], v8 offset:28672
    s_waitcnt lgkmcnt(10)
    v_mfma_f32_16x16x32_bf16 v[120:123], v[40:43], v[60:63], v[120:123]
    ds_read_b64_tr_b16 v[88:89], v4 offset:24576
    v_mfma_f32_16x16x32_bf16 v[124:127], v[44:47], v[60:63], v[124:127]
    ds_read_b64_tr_b16 v[90:91], v4 offset:28672
    s_waitcnt vmcnt(9) lgkmcnt(4)
    s_barrier
    v_mfma_f32_16x16x32_bf16 v[112:115], v[48:51], v[56:59], v[112:115]
    ds_read_b64_tr_b16 v[76:77], v9 offset:24576
    s_add_u32 m0, s63, 16384
    s_nop 0
    buffer_load_dwordx4 v13, s[36:39], s65 offen lds
    v_mfma_f32_16x16x32_bf16 v[128:131], v[48:51], v[60:63], v[128:131]
    ds_read_b64_tr_b16 v[78:79], v9 offset:28672
    v_mfma_f32_16x16x32_bf16 v[136:139], v[40:43], v[64:67], v[136:139]
    ds_read_b64_tr_b16 v[92:93], v5 offset:24576
    s_add_u32 m0, s63, 65536
    s_nop 0
    buffer_load_dwordx4 v13, s[40:43], s65 offen lds
    v_mfma_f32_16x16x32_bf16 v[140:143], v[44:47], v[64:67], v[140:143]
    ds_read_b64_tr_b16 v[94:95], v5 offset:28672
    v_mfma_f32_16x16x32_bf16 v[144:147], v[48:51], v[64:67], v[144:147]
    ds_read_b64_tr_b16 v[80:81], v10 offset:24576
    s_add_u32 m0, s63, 114688
    s_add_u32 s65, s65, 114688
    buffer_load_dwordx4 v12, s[32:35], s64 offen sc1 lds
    s_add_u32 s64, s64, 8192
    v_mfma_f32_16x16x32_bf16 v[116:119], v[52:55], v[56:59], v[116:119]
    ds_read_b64_tr_b16 v[82:83], v10 offset:28672
    v_mfma_f32_16x16x32_bf16 v[132:135], v[52:55], v[60:63], v[132:135]
    ds_read_b64_tr_b16 v[96:97], v6 offset:24576
    v_mfma_f32_16x16x32_bf16 v[148:151], v[52:55], v[64:67], v[148:151]
    ds_read_b64_tr_b16 v[98:99], v6 offset:28672
    v_mfma_f32_16x16x32_bf16 v[152:155], v[40:43], v[68:71], v[152:155]
    ds_read_b64_tr_b16 v[84:85], v11 offset:24576
    v_mfma_f32_16x16x32_bf16 v[156:159], v[44:47], v[68:71], v[156:159]
    ds_read_b64_tr_b16 v[86:87], v11 offset:28672
    v_mfma_f32_16x16x32_bf16 v[160:163], v[48:51], v[68:71], v[160:163]
    ds_read_b64_tr_b16 v[100:101], v7 offset:24576
    v_mfma_f32_16x16x32_bf16 v[164:167], v[52:55], v[68:71], v[164:167]
    ds_read_b64_tr_b16 v[102:103], v7 offset:28672
    s_waitcnt lgkmcnt(12)
    v_mfma_f32_16x16x32_bf16 v[104:107], v[72:75], v[88:91], v[104:107]
    ds_read_b64_tr_b16 v[40:41], v8 offset:32768
    s_waitcnt lgkmcnt(11)
    v_mfma_f32_16x16x32_bf16 v[108:111], v[76:79], v[88:91], v[108:111]
    ds_read_b64_tr_b16 v[42:43], v8 offset:36864
    s_waitcnt lgkmcnt(10)
    v_mfma_f32_16x16x32_bf16 v[120:123], v[72:75], v[92:95], v[120:123]
    ds_read_b64_tr_b16 v[56:57], v4 offset:32768
    v_mfma_f32_16x16x32_bf16 v[124:127], v[76:79], v[92:95], v[124:127]
    ds_read_b64_tr_b16 v[58:59], v4 offset:36864
    s_waitcnt vmcnt(9) lgkmcnt(4)
    s_barrier
    v_mfma_f32_16x16x32_bf16 v[112:115], v[80:83], v[88:91], v[112:115]
    ds_read_b64_tr_b16 v[44:45], v9 offset:32768
    s_add_u32 m0, s63, 24576
    s_nop 0
    buffer_load_dwordx4 v13, s[36:39], s65 offen lds
    v_mfma_f32_16x16x32_bf16 v[128:131], v[80:83], v[92:95], v[128:131]
    ds_read_b64_tr_b16 v[46:47], v9 offset:36864
    v_mfma_f32_16x16x32_bf16 v[136:139], v[72:75], v[96:99], v[136:139]
    ds_read_b64_tr_b16 v[60:61], v5 offset:32768
    s_add_u32 m0, s63, 73728
    s_nop 0
    buffer_load_dwordx4 v13, s[40:43], s65 offen lds
    v_mfma_f32_16x16x32_bf16 v[140:143], v[76:79], v[96:99], v[140:143]
    ds_read_b64_tr_b16 v[62:63], v5 offset:36864
    v_mfma_f32_16x16x32_bf16 v[144:147], v[80:83], v[96:99], v[144:147]
    ds_read_b64_tr_b16 v[48:49], v10 offset:32768
    s_add_u32 m0, s63, 122880
    s_add_u32 s65, s65, 114688
    buffer_load_dwordx4 v12, s[32:35], s64 offen sc1 lds
    s_add_u32 s64, s64, 8192
    v_mfma_f32_16x16x32_bf16 v[116:119], v[84:87], v[88:91], v[116:119]
    ds_read_b64_tr_b16 v[50:51], v10 offset:36864
    v_mfma_f32_16x16x32_bf16 v[132:135], v[84:87], v[92:95], v[132:135]
    ds_read_b64_tr_b16 v[64:65], v6 offset:32768
    v_mfma_f32_16x16x32_bf16 v[148:151], v[84:87], v[96:99], v[148:151]
    ds_read_b64_tr_b16 v[66:67], v6 offset:36864
    v_mfma_f32_16x16x32_bf16 v[152:155], v[72:75], v[100:103], v[152:155]
    ds_read_b64_tr_b16 v[52:53], v11 offset:32768
    v_mfma_f32_16x16x32_bf16 v[156:159], v[76:79], v[100:103], v[156:159]
    ds_read_b64_tr_b16 v[54:55], v11 offset:36864
    v_mfma_f32_16x16x32_bf16 v[160:163], v[80:83], v[100:103], v[160:163]
    ds_read_b64_tr_b16 v[68:69], v7 offset:32768
    v_mfma_f32_16x16x32_bf16 v[164:167], v[84:87], v[100:103], v[164:167]
    ds_read_b64_tr_b16 v[70:71], v7 offset:36864
    s_waitcnt lgkmcnt(12)
    v_mfma_f32_16x16x32_bf16 v[104:107], v[40:43], v[56:59], v[104:107]
    ds_read_b64_tr_b16 v[72:73], v8 offset:40960
    s_waitcnt lgkmcnt(11)
    v_mfma_f32_16x16x32_bf16 v[108:111], v[44:47], v[56:59], v[108:111]
    ds_read_b64_tr_b16 v[74:75], v8 offset:45056
    s_waitcnt lgkmcnt(10)
    v_mfma_f32_16x16x32_bf16 v[120:123], v[40:43], v[60:63], v[120:123]
    ds_read_b64_tr_b16 v[88:89], v4 offset:40960
    v_mfma_f32_16x16x32_bf16 v[124:127], v[44:47], v[60:63], v[124:127]
    ds_read_b64_tr_b16 v[90:91], v4 offset:45056
    s_waitcnt vmcnt(9) lgkmcnt(4)
    s_barrier
    v_mfma_f32_16x16x32_bf16 v[112:115], v[48:51], v[56:59], v[112:115]
    ds_read_b64_tr_b16 v[76:77], v9 offset:40960
    s_add_u32 m0, s3, 49152
    s_nop 0
    buffer_load_dwordx4 v248, s[52:55], s30 offen lds
    v_mfma_f32_16x16x32_bf16 v[128:131], v[48:51], v[60:63], v[128:131]
    ds_read_b64_tr_b16 v[78:79], v9 offset:45056
    v_mfma_f32_16x16x32_bf16 v[136:139], v[40:43], v[64:67], v[136:139]
    ds_read_b64_tr_b16 v[92:93], v5 offset:40960
    buffer_load_dwordx4 v249, s[52:55], s30 offen offset:1024 lds
    s_add_u32 s30, s30, 32768
    v_mfma_f32_16x16x32_bf16 v[140:143], v[44:47], v[64:67], v[140:143]
    ds_read_b64_tr_b16 v[94:95], v5 offset:45056
    v_mfma_f32_16x16x32_bf16 v[144:147], v[48:51], v[64:67], v[144:147]
    ds_read_b64_tr_b16 v[80:81], v10 offset:40960
    s_add_u32 m0, s31, 32768
    s_nop 0
    buffer_load_dwordx4 v248, s[52:55], s30 offen lds
    v_mfma_f32_16x16x32_bf16 v[116:119], v[52:55], v[56:59], v[116:119]
    ds_read_b64_tr_b16 v[82:83], v10 offset:45056
    v_mfma_f32_16x16x32_bf16 v[132:135], v[52:55], v[60:63], v[132:135]
    ds_read_b64_tr_b16 v[96:97], v6 offset:40960
    buffer_load_dwordx4 v249, s[52:55], s30 offen offset:1024 lds
    s_add_u32 s30, s30, 32768
    v_mfma_f32_16x16x32_bf16 v[148:151], v[52:55], v[64:67], v[148:151]
    ds_read_b64_tr_b16 v[98:99], v6 offset:45056
    v_mfma_f32_16x16x32_bf16 v[152:155], v[40:43], v[68:71], v[152:155]
    ds_read_b64_tr_b16 v[84:85], v11 offset:40960
    v_mfma_f32_16x16x32_bf16 v[156:159], v[44:47], v[68:71], v[156:159]
    ds_read_b64_tr_b16 v[86:87], v11 offset:45056
    v_mfma_f32_16x16x32_bf16 v[160:163], v[48:51], v[68:71], v[160:163]
    ds_read_b64_tr_b16 v[100:101], v7 offset:40960
    v_mfma_f32_16x16x32_bf16 v[164:167], v[52:55], v[68:71], v[164:167]
    ds_read_b64_tr_b16 v[102:103], v7 offset:45056
    s_waitcnt lgkmcnt(12)
    v_mfma_f32_16x16x32_bf16 v[104:107], v[72:75], v[88:91], v[104:107]
    ds_read_b64_tr_b16 v[40:41], v8 offset:0
    s_waitcnt lgkmcnt(11)
    v_mfma_f32_16x16x32_bf16 v[108:111], v[76:79], v[88:91], v[108:111]
    ds_read_b64_tr_b16 v[42:43], v8 offset:4096
    s_waitcnt lgkmcnt(10)
    v_mfma_f32_16x16x32_bf16 v[120:123], v[72:75], v[92:95], v[120:123]
    ds_read_b64_tr_b16 v[56:57], v4 offset:0
    v_mfma_f32_16x16x32_bf16 v[124:127], v[76:79], v[92:95], v[124:127]
    ds_read_b64_tr_b16 v[58:59], v4 offset:4096
    s_waitcnt vmcnt(10) lgkmcnt(4)
    s_barrier
    v_mfma_f32_16x16x32_bf16 v[112:115], v[80:83], v[88:91], v[112:115]
    ds_read_b64_tr_b16 v[44:45], v9 offset:0
    buffer_load_dword v1, v16, s[84:87], s73 offen offset:36 sc1
    v_mfma_f32_16x16x32_bf16 v[128:131], v[80:83], v[92:95], v[128:131]
    ds_read_b64_tr_b16 v[46:47], v9 offset:4096
    v_mfma_f32_16x16x32_bf16 v[136:139], v[72:75], v[96:99], v[136:139]
    ds_read_b64_tr_b16 v[60:61], v5 offset:0
    s_add_u32 m0, s31, 40960
    s_nop 0
    buffer_load_dwordx4 v248, s[52:55], s30 offen lds
    v_mfma_f32_16x16x32_bf16 v[140:143], v[76:79], v[96:99], v[140:143]
    ds_read_b64_tr_b16 v[62:63], v5 offset:4096
    v_mfma_f32_16x16x32_bf16 v[144:147], v[80:83], v[96:99], v[144:147]
    ds_read_b64_tr_b16 v[48:49], v10 offset:0
    buffer_load_dwordx4 v249, s[52:55], s30 offen offset:1024 lds
    s_add_u32 s30, s30, 32768
    v_mfma_f32_16x16x32_bf16 v[116:119], v[84:87], v[88:91], v[116:119]
    ds_read_b64_tr_b16 v[50:51], v10 offset:4096
    v_mfma_f32_16x16x32_bf16 v[132:135], v[84:87], v[92:95], v[132:135]
    ds_read_b64_tr_b16 v[64:65], v6 offset:0
    s_add_u32 m0, s3, 32768
    s_nop 0
    buffer_load_dwordx4 v248, s[52:55], s30 offen lds
    v_mfma_f32_16x16x32_bf16 v[148:151], v[84:87], v[96:99], v[148:151]
    ds_read_b64_tr_b16 v[66:67], v6 offset:4096
    v_mfma_f32_16x16x32_bf16 v[152:155], v[72:75], v[100:103], v[152:155]
    ds_read_b64_tr_b16 v[52:53], v11 offset:0
    buffer_load_dwordx4 v249, s[52:55], s30 offen offset:1024 lds
    s_add_u32 s30, s30, 32768
    v_mfma_f32_16x16x32_bf16 v[156:159], v[76:79], v[100:103], v[156:159]
    ds_read_b64_tr_b16 v[54:55], v11 offset:4096
    v_mfma_f32_16x16x32_bf16 v[160:163], v[80:83], v[100:103], v[160:163]
    ds_read_b64_tr_b16 v[68:69], v7 offset:0
    v_mfma_f32_16x16x32_bf16 v[164:167], v[84:87], v[100:103], v[164:167]
    ds_read_b64_tr_b16 v[70:71], v7 offset:4096
    s_waitcnt lgkmcnt(12)
    v_mfma_f32_16x16x32_bf16 v[104:107], v[40:43], v[56:59], v[104:107]
    ds_read_b64_tr_b16 v[72:73], v8 offset:8192
    s_waitcnt lgkmcnt(11)
    v_mfma_f32_16x16x32_bf16 v[108:111], v[44:47], v[56:59], v[108:111]
    ds_read_b64_tr_b16 v[74:75], v8 offset:12288
    s_waitcnt lgkmcnt(10)
    v_mfma_f32_16x16x32_bf16 v[120:123], v[40:43], v[60:63], v[120:123]
    ds_read_b64_tr_b16 v[88:89], v4 offset:8192
    v_mfma_f32_16x16x32_bf16 v[124:127], v[44:47], v[60:63], v[124:127]
    ds_read_b64_tr_b16 v[90:91], v4 offset:12288
    s_waitcnt vmcnt(4) lgkmcnt(4)
    s_barrier
    v_cmp_ne_u32 vcc, s100, v1
    s_cbranch_vccz L_csfx_25
L_poll_26:
    buffer_load_dword v1, v16, s[84:87], s73 offen offset:36 sc1
    s_sub_u32 s89, s89, 1
    s_cbranch_scc1 L_pollx_27
L_polly_28:
    s_waitcnt vmcnt(0)
    v_cmp_ne_u32 vcc, s100, v1
    s_cbranch_vccnz L_poll_26
L_pollx_27:
    s_max_i32 s89, s89, 0
L_csfx_25:
    v_mfma_f32_16x16x32_bf16 v[112:115], v[48:51], v[56:59], v[112:115]
    ds_read_b64_tr_b16 v[76:77], v9 offset:8192
    buffer_load_dwordx4 v[24:27], v17, s[48:51], s71 offen offset:0 sc1
    v_xor_b32 v19, 0, v18
    buffer_load_dword v20, v19, s[48:51], s69 offen sc1
    v_mfma_f32_16x16x32_bf16 v[128:131], v[48:51], v[60:63], v[128:131]
    ds_read_b64_tr_b16 v[78:79], v9 offset:12288
    v_mfma_f32_16x16x32_bf16 v[136:139], v[40:43], v[64:67], v[136:139]
    ds_read_b64_tr_b16 v[92:93], v5 offset:8192
    buffer_load_dwordx4 v[28:31], v17, s[48:51], s71 offen offset:64 sc1
    v_xor_b32 v19, 64, v18
    buffer_load_dword v21, v19, s[48:51], s69 offen sc1
    v_mfma_f32_16x16x32_bf16 v[140:143], v[44:47], v[64:67], v[140:143]
    ds_read_b64_tr_b16 v[94:95], v5 offset:12288
    v_mfma_f32_16x16x32_bf16 v[144:147], v[48:51], v[64:67], v[144:147]
    ds_read_b64_tr_b16 v[80:81], v10 offset:8192
    buffer_load_dwordx4 v[32:35], v17, s[48:51], s72 offen offset:0 sc1
    v_xor_b32 v19, 128, v18
    buffer_load_dword v22, v19, s[48:51], s69 offen sc1
    v_mfma_f32_16x16x32_bf16 v[116:119], v[52:55], v[56:59], v[116:119]
    ds_read_b64_tr_b16 v[82:83], v10 offset:12288
    v_mfma_f32_16x16x32_bf16 v[132:135], v[52:55], v[60:63], v[132:135]
    ds_read_b64_tr_b16 v[96:97], v6 offset:8192
    buffer_load_dwordx4 v[36:39], v17, s[48:51], s72 offen offset:64 sc1
    v_xor_b32 v19, 192, v18
    buffer_load_dword v23, v19, s[48:51], s69 offen sc1
    v_mfma_f32_16x16x32_bf16 v[148:151], v[52:55], v[64:67], v[148:151]
    ds_read_b64_tr_b16 v[98:99], v6 offset:12288
    v_mfma_f32_16x16x32_bf16 v[152:155], v[40:43], v[68:71], v[152:155]
    ds_read_b64_tr_b16 v[84:85], v11 offset:8192
    s_add_u32 m0, s31, 0
    s_nop 0
    buffer_load_dwordx4 v248, s[52:55], s30 offen lds
    v_mfma_f32_16x16x32_bf16 v[156:159], v[44:47], v[68:71], v[156:159]
    ds_read_b64_tr_b16 v[86:87], v11 offset:12288
    v_mfma_f32_16x16x32_bf16 v[160:163], v[48:51], v[68:71], v[160:163]
    ds_read_b64_tr_b16 v[100:101], v7 offset:8192
    buffer_load_dwordx4 v249, s[52:55], s30 offen offset:1024 lds
    s_add_u32 s30, s30, 32768
    v_mfma_f32_16x16x32_bf16 v[164:167], v[52:55], v[68:71], v[164:167]
    ds_read_b64_tr_b16 v[102:103], v7 offset:12288
    s_waitcnt lgkmcnt(12)
    v_mfma_f32_16x16x32_bf16 v[104:107], v[72:75], v[88:91], v[104:107]
    ds_read_b64_tr_b16 v[40:41], v8 offset:16384
    s_waitcnt lgkmcnt(11)
    v_mfma_f32_16x16x32_bf16 v[108:111], v[76:79], v[88:91], v[108:111]
    ds_read_b64_tr_b16 v[42:43], v8 offset:20480
    s_waitcnt lgkmcnt(10)
    v_mfma_f32_16x16x32_bf16 v[120:123], v[72:75], v[92:95], v[120:123]
    ds_read_b64_tr_b16 v[56:57], v4 offset:16384
    v_mfma_f32_16x16x32_bf16 v[124:127], v[76:79], v[92:95], v[124:127]
    ds_read_b64_tr_b16 v[58:59], v4 offset:20480
    s_waitcnt vmcnt(14) lgkmcnt(4)
    s_barrier
    v_mfma_f32_16x16x32_bf16 v[112:115], v[80:83], v[88:91], v[112:115]
    ds_read_b64_tr_b16 v[44:45], v9 offset:16384
    s_add_u32 m0, s31, 8192
    s_nop 0
    buffer_load_dwordx4 v248, s[52:55], s30 offen lds
    v_mfma_f32_16x16x32_bf16 v[128:131], v[80:83], v[92:95], v[128:131]
    ds_read_b64_tr_b16 v[46:47], v9 offset:20480
    v_mfma_f32_16x16x32_bf16 v[136:139], v[72:75], v[96:99], v[136:139]
    ds_read_b64_tr_b16 v[60:61], v5 offset:16384
    buffer_load_dwordx4 v249, s[52:55], s30 offen offset:1024 lds
    s_add_u32 s30, s30, 32768
    v_mfma_f32_16x16x32_bf16 v[140:143], v[76:79], v[96:99], v[140:143]
    ds_read_b64_tr_b16 v[62:63], v5 offset:20480
    v_mfma_f32_16x16x32_bf16 v[144:147], v[80:83], v[96:99], v[144:147]
    ds_read_b64_tr_b16 v[48:49], v10 offset:16384
    s_add_u32 m0, s3, 0
    s_nop 0
    buffer_load_dwordx4 v248, s[52:55], s30 offen lds
    v_mfma_f32_16x16x32_bf16 v[116:119], v[84:87], v[88:91], v[116:119]
    ds_read_b64_tr_b16 v[50:51], v10 offset:20480
    v_mfma_f32_16x16x32_bf16 v[132:135], v[84:87], v[92:95], v[132:135]
    ds_read_b64_tr_b16 v[64:65], v6 offset:16384
    buffer_load_dwordx4 v249, s[52:55], s30 offen offset:1024 lds
    s_add_u32 s30, s30, 32768
    v_mfma_f32_16x16x32_bf16 v[148:151], v[84:87], v[96:99], v[148:151]
    ds_read_b64_tr_b16 v[66:67], v6 offset:20480
    v_mfma_f32_16x16x32_bf16 v[152:155], v[72:75], v[100:103], v[152:155]
    ds_read_b64_tr_b16 v[52:53], v11 offset:16384
    v_mfma_f32_16x16x32_bf16 v[156:159], v[76:79], v[100:103], v[156:159]
    ds_read_b64_tr_b16 v[54:55], v11 offset:20480
    v_mfma_f32_16x16x32_bf16 v[160:163], v[80:83], v[100:103], v[160:163]
    ds_read_b64_tr_b16 v[68:69], v7 offset:16384
    v_mfma_f32_16x16x32_bf16 v[164:167], v[84:87], v[100:103], v[164:167]
    ds_read_b64_tr_b16 v[70:71], v7 offset:20480
    s_waitcnt lgkmcnt(12)
    v_mfma_f32_16x16x32_bf16 v[104:107], v[40:43], v[56:59], v[104:107]
    ds_read_b64_tr_b16 v[72:73], v8 offset:24576
    s_waitcnt lgkmcnt(11)
    v_mfma_f32_16x16x32_bf16 v[108:111], v[44:47], v[56:59], v[108:111]
    ds_read_b64_tr_b16 v[74:75], v8 offset:28672
    s_waitcnt lgkmcnt(10)
    v_mfma_f32_16x16x32_bf16 v[120:123], v[40:43], v[60:63], v[120:123]
    ds_read_b64_tr_b16 v[88:89], v4 offset:24576
    v_mfma_f32_16x16x32_bf16 v[124:127], v[44:47], v[60:63], v[124:127]
    ds_read_b64_tr_b16 v[90:91], v4 offset:28672
    s_waitcnt vmcnt(18) lgkmcnt(4)
    s_barrier
    v_mfma_f32_16x16x32_bf16 v[112:115], v[48:51], v[56:59], v[112:115]
    ds_read_b64_tr_b16 v[76:77], v9 offset:24576
    s_add_u32 m0, s31, 16384
    s_nop 0
    buffer_load_dwordx4 v248, s[52:55], s30 offen lds
    v_mfma_f32_16x16x32_bf16 v[128:131], v[48:51], v[60:63], v[128:131]
    ds_read_b64_tr_b16 v[78:79], v9 offset:28672
    v_mfma_f32_16x16x32_bf16 v[136:139], v[40:43], v[64:67], v[136:139]
    ds_read_b64_tr_b16 v[92:93], v5 offset:24576
    buffer_load_dwordx4 v249, s[52:55], s30 offen offset:1024 lds
    s_add_u32 s30, s30, 32768
    v_mfma_f32_16x16x32_bf16 v[140:143], v[44:47], v[64:67], v[140:143]
    ds_read_b64_tr_b16 v[94:95], v5 offset:28672
    v_mfma_f32_16x16x32_bf16 v[144:147], v[48:51], v[64:67], v[144:147]
    ds_read_b64_tr_b16 v[80:81], v10 offset:24576
    v_mfma_f32_16x16x32_bf16 v[116:119], v[52:55], v[56:59], v[116:119]
    ds_read_b64_tr_b16 v[82:83], v10 offset:28672
    v_mfma_f32_16x16x32_bf16 v[132:135], v[52:55], v[60:63], v[132:135]
    ds_read_b64_tr_b16 v[96:97], v6 offset:24576
    v_mfma_f32_16x16x32_bf16 v[148:151], v[52:55], v[64:67], v[148:151]
    ds_read_b64_tr_b16 v[98:99], v6 offset:28672
    v_mfma_f32_16x16x32_bf16 v[152:155], v[40:43], v[68:71], v[152:155]
    ds_read_b64_tr_b16 v[84:85], v11 offset:24576
    v_mfma_f32_16x16x32_bf16 v[156:159], v[44:47], v[68:71], v[156:159]
    ds_read_b64_tr_b16 v[86:87], v11 offset:28672
    v_mfma_f32_16x16x32_bf16 v[160:163], v[48:51], v[68:71], v[160:163]
    ds_read_b64_tr_b16 v[100:101], v7 offset:24576
    v_mfma_f32_16x16x32_bf16 v[164:167], v[52:55], v[68:71], v[164:167]
    ds_read_b64_tr_b16 v[102:103], v7 offset:28672
    s_waitcnt lgkmcnt(12)
    v_mfma_f32_16x16x32_bf16 v[104:107], v[72:75], v[88:91], v[104:107]
    v_mov_b32 v4, v168
    v_mov_b32 v5, v169
    v_mov_b32 v6, v170
    v_mov_b32 v7, v171
    v_mov_b32 v8, v172
    s_waitcnt lgkmcnt(10)
    v_mfma_f32_16x16x32_bf16 v[108:111], v[76:79], v[88:91], v[108:111]
    v_mov_b32 v9, v173
    v_mov_b32 v10, v174
    v_mov_b32 v11, v175
    s_waitcnt lgkmcnt(8)
    v_mfma_f32_16x16x32_bf16 v[120:123], v[72:75], v[92:95], v[120:123]
    v_mfma_f32_16x16x32_bf16 v[124:127], v[76:79], v[92:95], v[124:127]
    s_waitcnt vmcnt(8) lgkmcnt(0)
    s_barrier
    v_mfma_f32_16x16x32_bf16 v[112:115], v[80:83], v[88:91], v[112:115]
    ds_read_b64_tr_b16 v[56:57], v8 offset:49152
    s_add_u32 m0, s31, 24576
    s_nop 0
    buffer_load_dwordx4 v248, s[52:55], s30 offen lds
    v_and_b32 v41, s70, v20
    v_rcp_f32 v42, v41
    v_lshlrev_b32 v40, 16, v20
    v_mfma_f32_16x16x32_bf16 v[128:131], v[80:83], v[92:95], v[128:131]
    ds_read_b64_tr_b16 v[58:59], v8 offset:51200
    v_mul_f32 v41, v41, v41
    v_mul_f32 v43, v42, v42
    v_mul_f32 v43, s78, v43
    v_mfma_f32_16x16x32_bf16 v[136:139], v[72:75], v[96:99], v[136:139]
    ds_read_b64_tr_b16 v[60:61], v9 offset:49152
    buffer_load_dwordx4 v249, s[52:55], s30 offen offset:1024 lds
    s_add_u32 s30, s30, 32768
    v_mul_f32 v43, v43, v42
    v_mul_f32 v42, s77, v42
    v_and_b32 v45, s70, v21
    v_mfma_f32_16x16x32_bf16 v[140:143], v[76:79], v[96:99], v[140:143]
    ds_read_b64_tr_b16 v[62:63], v9 offset:51200
    v_rcp_f32 v46, v45
    v_lshlrev_b32 v44, 16, v21
    v_mul_f32 v45, v45, v45
    v_mfma_f32_16x16x32_bf16 v[144:147], v[80:83], v[96:99], v[144:147]
    ds_read_b64_tr_b16 v[64:65], v10 offset:49152
    s_add_u32 m0, s3, 16384
    s_nop 0
    buffer_load_dwordx4 v248, s[52:55], s30 offen lds
    v_mul_f32 v47, v46, v46
    v_mul_f32 v47, s78, v47
    v_mul_f32 v47, v47, v46
    v_mfma_f32_16x16x32_bf16 v[116:119], v[84:87], v[88:91], v[116:119]
    ds_read_b64_tr_b16 v[66:67], v10 offset:51200
    v_mul_f32 v46, s77, v46
    v_and_b32 v49, s70, v22
    v_rcp_f32 v50, v49
    v_mfma_f32_16x16x32_bf16 v[132:135], v[84:87], v[92:95], v[132:135]
    ds_read_b64_tr_b16 v[68:69], v11 offset:49152
    buffer_load_dwordx4 v249, s[52:55], s30 offen offset:1024 lds
    s_add_u32 s30, s30, 32768
    v_lshlrev_b32 v48, 16, v22
    v_mul_f32 v49, v49, v49
    v_mul_f32 v51, v50, v50
    v_mfma_f32_16x16x32_bf16 v[148:151], v[84:87], v[96:99], v[148:151]
    ds_read_b64_tr_b16 v[70:71], v11 offset:51200
    v_mul_f32 v51, s78, v51
    v_mul_f32 v51, v51, v50
    v_mul_f32 v50, s77, v50
    v_mfma_f32_16x16x32_bf16 v[152:155], v[72:75], v[100:103], v[152:155]
    v_and_b32 v53, s70, v23
    v_rcp_f32 v54, v53
    v_lshlrev_b32 v52, 16, v23
    v_mfma_f32_16x16x32_bf16 v[156:159], v[76:79], v[100:103], v[156:159]
    v_mul_f32 v53, v53, v53
    v_mul_f32 v55, v54, v54
    v_mul_f32 v55, s78, v55
    v_mfma_f32_16x16x32_bf16 v[160:163], v[80:83], v[100:103], v[160:163]
    v_mul_f32 v55, v55, v54
    v_mul_f32 v54, s77, v54
    v_mfma_f32_16x16x32_bf16 v[164:167], v[84:87], v[100:103], v[164:167]
    v_pk_fma_f32 v[104:105], v[24:25], v[40:41], v[104:105] op_sel_hi:[1,0,1] neg_lo:[0,1,0] neg_hi:[0,1,0]
    v_pk_fma_f32 v[106:107], v[26:27], v[40:41], v[106:107] op_sel_hi:[1,0,1] neg_lo:[0,1,0] neg_hi:[0,1,0]
    v_pk_fma_f32 v[108:109], v[28:29], v[40:41], v[108:109] op_sel_hi:[1,0,1] neg_lo:[0,1,0] neg_hi:[0,1,0]
    v_pk_fma_f32 v[110:111], v[30:31], v[40:41], v[110:111] op_sel_hi:[1,0,1] neg_lo:[0,1,0] neg_hi:[0,1,0]
    v_pk_fma_f32 v[112:113], v[32:33], v[40:41], v[112:113] op_sel_hi:[1,0,1] neg_lo:[0,1,0] neg_hi:[0,1,0]
    v_pk_fma_f32 v[114:115], v[34:35], v[40:41], v[114:115] op_sel_hi:[1,0,1] neg_lo:[0,1,0] neg_hi:[0,1,0]
    v_pk_fma_f32 v[116:117], v[36:37], v[40:41], v[116:117] op_sel_hi:[1,0,1] neg_lo:[0,1,0] neg_hi:[0,1,0]
    v_pk_fma_f32 v[118:119], v[38:39], v[40:41], v[118:119] op_sel_hi:[1,0,1] neg_lo:[0,1,0] neg_hi:[0,1,0]
    v_pk_mul_f32 v[168:169], v[104:105], v[104:105]
    v_pk_mul_f32 v[170:171], v[106:107], v[106:107]
    v_pk_mul_f32 v[172:173], v[108:109], v[108:109]
    v_pk_mul_f32 v[174:175], v[110:111], v[110:111]
    v_pk_fma_f32 v[168:169], v[168:169], v[42:43], v[42:43] op_sel:[0,1,0] op_sel_hi:[1,1,0]
    v_pk_fma_f32 v[170:171], v[170:171], v[42:43], v[42:43] op_sel:[0,1,0] op_sel_hi:[1,1,0]
    v_pk_fma_f32 v[172:173], v[172:173], v[42:43], v[42:43] op_sel:[0,1,0] op_sel_hi:[1,1,0]
    v_pk_fma_f32 v[174:175], v[174:175], v[42:43], v[42:43] op_sel:[0,1,0] op_sel_hi:[1,1,0]
    v_pk_mul_f32 v[168:169], v[168:169], v[104:105]
    v_pk_mul_f32 v[170:171], v[170:171], v[106:107]
    v_pk_mul_f32 v[172:173], v[172:173], v[108:109]
    v_pk_mul_f32 v[174:175], v[174:175], v[110:111]
    v_exp_f32 v168, v168
    v_exp_f32 v169, v169
    v_pk_mul_f32 v[104:105], v[104:105], v[112:113]
    v_exp_f32 v170, v170
    v_exp_f32 v171, v171
    v_pk_mul_f32 v[106:107], v[106:107], v[114:115]
    v_exp_f32 v172, v172
    v_exp_f32 v173, v173
    v_pk_mul_f32 v[108:109], v[108:109], v[116:117]
    v_exp_f32 v174, v174
    v_exp_f32 v175, v175
    v_pk_mul_f32 v[110:111], v[110:111], v[118:119]
    v_pk_fma_f32 v[168:169], v[168:169], v[40:41], v[40:41] op_sel:[0,1,1] op_sel_hi:[1,1,1]
    v_pk_fma_f32 v[170:171], v[170:171], v[40:41], v[40:41] op_sel:[0,1,1] op_sel_hi:[1,1,1]
    v_pk_fma_f32 v[172:173], v[172:173], v[40:41], v[40:41] op_sel:[0,1,1] op_sel_hi:[1,1,1]
    v_pk_fma_f32 v[174:175], v[174:175], v[40:41], v[40:41] op_sel:[0,1,1] op_sel_hi:[1,1,1]
    v_rcp_f32 v168, v168
    v_rcp_f32 v169, v169
    v_rcp_f32 v170, v170
    v_rcp_f32 v171, v171
    v_rcp_f32 v172, v172
    v_rcp_f32 v173, v173
    v_rcp_f32 v174, v174
    v_rcp_f32 v175, v175
    v_pk_mul_f32 v[104:105], v[104:105], v[168:169]
    v_pk_mul_f32 v[106:107], v[106:107], v[170:171]
    v_pk_mul_f32 v[108:109], v[108:109], v[172:173]
    v_pk_mul_f32 v[110:111], v[110:111], v[174:175]
    v_cvt_pk_bf16_f32 v184, v104, v105
    v_cvt_pk_bf16_f32 v185, v106, v107
    v_cvt_pk_bf16_f32 v186, v108, v109
    v_cvt_pk_bf16_f32 v187, v110, v111
    buffer_store_dwordx4 v[184:187], v253, s[44:47], s80 offen sc1
    v_pk_fma_f32 v[120:121], v[24:25], v[44:45], v[120:121] op_sel_hi:[1,0,1] neg_lo:[0,1,0] neg_hi:[0,1,0]
    v_pk_fma_f32 v[122:123], v[26:27], v[44:45], v[122:123] op_sel_hi:[1,0,1] neg_lo:[0,1,0] neg_hi:[0,1,0]
    v_pk_fma_f32 v[124:125], v[28:29], v[44:45], v[124:125] op_sel_hi:[1,0,1] neg_lo:[0,1,0] neg_hi:[0,1,0]
    v_pk_fma_f32 v[126:127], v[30:31], v[44:45], v[126:127] op_sel_hi:[1,0,1] neg_lo:[0,1,0] neg_hi:[0,1,0]
    v_pk_fma_f32 v[128:129], v[32:33], v[44:45], v[128:129] op_sel_hi:[1,0,1] neg_lo:[0,1,0] neg_hi:[0,1,0]
    v_pk_fma_f32 v[130:131], v[34:35], v[44:45], v[130:131] op_sel_hi:[1,0,1] neg_lo:[0,1,0] neg_hi:[0,1,0]
    v_pk_fma_f32 v[132:133], v[36:37], v[44:45], v[132:133] op_sel_hi:[1,0,1] neg_lo:[0,1,0] neg_hi:[0,1,0]
    v_pk_fma_f32 v[134:135], v[38:39], v[44:45], v[134:135] op_sel_hi:[1,0,1] neg_lo:[0,1,0] neg_hi:[0,1,0]
    v_pk_mul_f32 v[176:177], v[120:121], v[120:121]
    v_pk_mul_f32 v[178:179], v[122:123], v[122:123]
    v_pk_mul_f32 v[180:181], v[124:125], v[124:125]
    v_pk_mul_f32 v[182:183], v[126:127], v[126:127]
    v_pk_fma_f32 v[176:177], v[176:177], v[46:47], v[46:47] op_sel:[0,1,0] op_sel_hi:[1,1,0]
    v_pk_fma_f32 v[178:179], v[178:179], v[46:47], v[46:47] op_sel:[0,1,0] op_sel_hi:[1,1,0]
    v_pk_fma_f32 v[180:181], v[180:181], v[46:47], v[46:47] op_sel:[0,1,0] op_sel_hi:[1,1,0]
    v_pk_fma_f32 v[182:183], v[182:183], v[46:47], v[46:47] op_sel:[0,1,0] op_sel_hi:[1,1,0]
    v_pk_mul_f32 v[176:177], v[176:177], v[120:121]
    v_pk_mul_f32 v[178:179], v[178:179], v[122:123]
    v_pk_mul_f32 v[180:181], v[180:181], v[124:125]
    v_pk_mul_f32 v[182:183], v[182:183], v[126:127]
    v_exp_f32 v176, v176
    v_exp_f32 v177, v177
    v_pk_mul_f32 v[120:121], v[120:121], v[128:129]
    v_exp_f32 v178, v178
    v_exp_f32 v179, v179
    v_pk_mul_f32 v[122:123], v[122:123], v[130:131]
    v_exp_f32 v180, v180
    v_exp_f32 v181, v181
    v_pk_mul_f32 v[124:125], v[124:125], v[132:133]
    v_exp_f32 v182, v182
    v_exp_f32 v183, v183
    v_pk_mul_f32 v[126:127], v[126:127], v[134:135]
    v_pk_fma_f32 v[176:177], v[176:177], v[44:45], v[44:45] op_sel:[0,1,1] op_sel_hi:[1,1,1]
    v_pk_fma_f32 v[178:179], v[178:179], v[44:45], v[44:45] op_sel:[0,1,1] op_sel_hi:[1,1,1]
    v_pk_fma_f32 v[180:181], v[180:181], v[44:45], v[44:45] op_sel:[0,1,1] op_sel_hi:[1,1,1]
    v_pk_fma_f32 v[182:183], v[182:183], v[44:45], v[44:45] op_sel:[0,1,1] op_sel_hi:[1,1,1]
    v_rcp_f32 v176, v176
    v_rcp_f32 v177, v177
    v_rcp_f32 v178, v178
    v_rcp_f32 v179, v179
    v_rcp_f32 v180, v180
    v_rcp_f32 v181, v181
    v_rcp_f32 v182, v182
    v_rcp_f32 v183, v183
    v_pk_mul_f32 v[120:121], v[120:121], v[176:177]
    v_pk_mul_f32 v[122:123], v[122:123], v[178:179]
    v_pk_mul_f32 v[124:125], v[124:125], v[180:181]
    v_pk_mul_f32 v[126:127], v[126:127], v[182:183]
    v_cvt_pk_bf16_f32 v188, v120, v121
    v_cvt_pk_bf16_f32 v189, v122, v123
    v_cvt_pk_bf16_f32 v190, v124, v125
    v_cvt_pk_bf16_f32 v191, v126, v127
    buffer_store_dwordx4 v[188:191], v254, s[44:47], s81 offen sc1
    v_pk_fma_f32 v[136:137], v[24:25], v[48:49], v[136:137] op_sel_hi:[1,0,1] neg_lo:[0,1,0] neg_hi:[0,1,0]
    v_pk_fma_f32 v[138:139], v[26:27], v[48:49], v[138:139] op_sel_hi:[1,0,1] neg_lo:[0,1,0] neg_hi:[0,1,0]
    v_pk_fma_f32 v[140:141], v[28:29], v[48:49], v[140:141] op_sel_hi:[1,0,1] neg_lo:[0,1,0] neg_hi:[0,1,0]
    v_pk_fma_f32 v[142:143], v[30:31], v[48:49], v[142:143] op_sel_hi:[1,0,1] neg_lo:[0,1,0] neg_hi:[0,1,0]
    v_pk_fma_f32 v[144:145], v[32:33], v[48:49], v[144:145] op_sel_hi:[1,0,1] neg_lo:[0,1,0] neg_hi:[0,1,0]
    v_pk_fma_f32 v[146:147], v[34:35], v[48:49], v[146:147] op_sel_hi:[1,0,1] neg_lo:[0,1,0] neg_hi:[0,1,0]
    v_pk_fma_f32 v[148:149], v[36:37], v[48:49], v[148:149] op_sel_hi:[1,0,1] neg_lo:[0,1,0] neg_hi:[0,1,0]
    v_pk_fma_f32 v[150:151], v[38:39], v[48:49], v[150:151] op_sel_hi:[1,0,1] neg_lo:[0,1,0] neg_hi:[0,1,0]
    v_pk_mul_f32 v[168:169], v[136:137], v[136:137]
    v_pk_mul_f32 v[170:171], v[138:139], v[138:139]
    v_pk_mul_f32 v[172:173], v[140:141], v[140:141]
    v_pk_mul_f32 v[174:175], v[142:143], v[142:143]
    v_pk_fma_f32 v[168:169], v[168:169], v[50:51], v[50:51] op_sel:[0,1,0] op_sel_hi:[1,1,0]
    v_pk_fma_f32 v[170:171], v[170:171], v[50:51], v[50:51] op_sel:[0,1,0] op_sel_hi:[1,1,0]
    v_pk_fma_f32 v[172:173], v[172:173], v[50:51], v[50:51] op_sel:[0,1,0] op_sel_hi:[1,1,0]
    v_pk_fma_f32 v[174:175], v[174:175], v[50:51], v[50:51] op_sel:[0,1,0] op_sel_hi:[1,1,0]
    v_pk_mul_f32 v[168:169], v[168:169], v[136:137]
    v_pk_mul_f32 v[170:171], v[170:171], v[138:139]
    v_pk_mul_f32 v[172:173], v[172:173], v[140:141]
    v_pk_mul_f32 v[174:175], v[174:175], v[142:143]
    v_exp_f32 v168, v168
    v_exp_f32 v169, v169
    v_pk_mul_f32 v[136:137], v[136:137], v[144:145]
    v_exp_f32 v170, v170
    v_exp_f32 v171, v171
    v_pk_mul_f32 v[138:139], v[138:139], v[146:147]
    v_exp_f32 v172, v172
    v_exp_f32 v173, v173
    v_pk_mul_f32 v[140:141], v[140:141], v[148:149]
    v_exp_f32 v174, v174
    v_exp_f32 v175, v175
    v_pk_mul_f32 v[142:143], v[142:143], v[150:151]
    v_pk_fma_f32 v[168:169], v[168:169], v[48:49], v[48:49] op_sel:[0,1,1] op_sel_hi:[1,1,1]
    v_pk_fma_f32 v[170:171], v[170:171], v[48:49], v[48:49] op_sel:[0,1,1] op_sel_hi:[1,1,1]
    v_pk_fma_f32 v[172:173], v[172:173], v[48:49], v[48:49] op_sel:[0,1,1] op_sel_hi:[1,1,1]
    v_pk_fma_f32 v[174:175], v[174:175], v[48:49], v[48:49] op_sel:[0,1,1] op_sel_hi:[1,1,1]
    v_rcp_f32 v168, v168
    v_rcp_f32 v169, v169
    v_rcp_f32 v170, v170
    v_rcp_f32 v171, v171
    v_rcp_f32 v172, v172
    v_rcp_f32 v173, v173
    v_rcp_f32 v174, v174
    v_rcp_f32 v175, v175
    v_pk_mul_f32 v[136:137], v[136:137], v[168:169]
    v_pk_mul_f32 v[138:139], v[138:139], v[170:171]
    v_pk_mul_f32 v[140:141], v[140:141], v[172:173]
    v_pk_mul_f32 v[142:143], v[142:143], v[174:175]
    v_cvt_pk_bf16_f32 v192, v136, v137
    v_cvt_pk_bf16_f32 v193, v138, v139
    v_cvt_pk_bf16_f32 v194, v140, v141
    v_cvt_pk_bf16_f32 v195, v142, v143
    buffer_store_dwordx4 v[192:195], v253, s[44:47], s82 offen sc1
    v_pk_fma_f32 v[152:153], v[24:25], v[52:53], v[152:153] op_sel_hi:[1,0,1] neg_lo:[0,1,0] neg_hi:[0,1,0]
    v_pk_fma_f32 v[154:155], v[26:27], v[52:53], v[154:155] op_sel_hi:[1,0,1] neg_lo:[0,1,0] neg_hi:[0,1,0]
    v_pk_fma_f32 v[156:157], v[28:29], v[52:53], v[156:157] op_sel_hi:[1,0,1] neg_lo:[0,1,0] neg_hi:[0,1,0]
    v_pk_fma_f32 v[158:159], v[30:31], v[52:53], v[158:159] op_sel_hi:[1,0,1] neg_lo:[0,1,0] neg_hi:[0,1,0]
    v_pk_fma_f32 v[160:161], v[32:33], v[52:53], v[160:161] op_sel_hi:[1,0,1] neg_lo:[0,1,0] neg_hi:[0,1,0]
    v_pk_fma_f32 v[162:163], v[34:35], v[52:53], v[162:163] op_sel_hi:[1,0,1] neg_lo:[0,1,0] neg_hi:[0,1,0]
    v_pk_fma_f32 v[164:165], v[36:37], v[52:53], v[164:165] op_sel_hi:[1,0,1] neg_lo:[0,1,0] neg_hi:[0,1,0]
    v_pk_fma_f32 v[166:167], v[38:39], v[52:53], v[166:167] op_sel_hi:[1,0,1] neg_lo:[0,1,0] neg_hi:[0,1,0]
    v_pk_mul_f32 v[176:177], v[152:153], v[152:153]
    v_pk_mul_f32 v[178:179], v[154:155], v[154:155]
    v_pk_mul_f32 v[180:181], v[156:157], v[156:157]
    v_pk_mul_f32 v[182:183], v[158:159], v[158:159]
    v_pk_fma_f32 v[176:177], v[176:177], v[54:55], v[54:55] op_sel:[0,1,0] op_sel_hi:[1,1,0]
    v_pk_fma_f32 v[178:179], v[178:179], v[54:55], v[54:55] op_sel:[0,1,0] op_sel_hi:[1,1,0]
    v_pk_fma_f32 v[180:181], v[180:181], v[54:55], v[54:55] op_sel:[0,1,0] op_sel_hi:[1,1,0]
    v_pk_fma_f32 v[182:183], v[182:183], v[54:55], v[54:55] op_sel:[0,1,0] op_sel_hi:[1,1,0]
    v_pk_mul_f32 v[176:177], v[176:177], v[152:153]
    v_pk_mul_f32 v[178:179], v[178:179], v[154:155]
    v_pk_mul_f32 v[180:181], v[180:181], v[156:157]
    v_pk_mul_f32 v[182:183], v[182:183], v[158:159]
    v_exp_f32 v176, v176
    v_exp_f32 v177, v177
    v_pk_mul_f32 v[152:153], v[152:153], v[160:161]
    v_exp_f32 v178, v178
    v_exp_f32 v179, v179
    v_pk_mul_f32 v[154:155], v[154:155], v[162:163]
    v_exp_f32 v180, v180
    v_exp_f32 v181, v181
    v_pk_mul_f32 v[156:157], v[156:157], v[164:165]
    v_exp_f32 v182, v182
    v_exp_f32 v183, v183
    v_pk_mul_f32 v[158:159], v[158:159], v[166:167]
    v_pk_fma_f32 v[176:177], v[176:177], v[52:53], v[52:53] op_sel:[0,1,1] op_sel_hi:[1,1,1]
    v_pk_fma_f32 v[178:179], v[178:179], v[52:53], v[52:53] op_sel:[0,1,1] op_sel_hi:[1,1,1]
    v_pk_fma_f32 v[180:181], v[180:181], v[52:53], v[52:53] op_sel:[0,1,1] op_sel_hi:[1,1,1]
    v_pk_fma_f32 v[182:183], v[182:183], v[52:53], v[52:53] op_sel:[0,1,1] op_sel_hi:[1,1,1]
    v_rcp_f32 v176, v176
    v_rcp_f32 v177, v177
    v_rcp_f32 v178, v178
    v_rcp_f32 v179, v179
    v_rcp_f32 v180, v180
    v_rcp_f32 v181, v181
    v_rcp_f32 v182, v182
    v_rcp_f32 v183, v183
    v_pk_mul_f32 v[152:153], v[152:153], v[176:177]
    v_pk_mul_f32 v[154:155], v[154:155], v[178:179]
    v_pk_mul_f32 v[156:157], v[156:157], v[180:181]
    v_pk_mul_f32 v[158:159], v[158:159], v[182:183]
    v_cvt_pk_bf16_f32 v196, v152, v153
    v_cvt_pk_bf16_f32 v197, v154, v155
    v_cvt_pk_bf16_f32 v198, v156, v157
    v_cvt_pk_bf16_f32 v199, v158, v159
    buffer_store_dwordx4 v[196:199], v254, s[44:47], s83 offen sc1
    s_waitcnt vmcnt(0) lgkmcnt(0)
    s_barrier
    s_cmp_lg_u32 s88, 0
    s_cbranch_scc1 L_noarr_29
    v_mov_b32 v251, s100
    s_mul_i32 s90, s79, 128
    s_mov_b64 exec, 1
    buffer_store_dword v251, off, s[84:87], s90 offset:32 sc1
    s_mov_b64 exec, -1
L_noarr_29:
    s_add_u32 m0, s3, 49152
    s_nop 0
    buffer_load_dwordx4 v248, s[52:55], s30 offen lds
    buffer_load_dwordx4 v249, s[52:55], s30 offen offset:1024 lds
    s_add_u32 s30, s30, 32768
L_p3:
    s_and_b32 s56, s2, 7
    s_and_b32 s58, s56, 3
    s_lshl_b32 s58, s58, 1
    s_lshr_b32 s56, s56, 2
    s_add_u32 s58, s58, s56
    s_lshl_b32 s58, s58, 2
    s_and_b32 s59, s57, 3
    s_add_u32 s58, s58, s59
    s_lshr_b32 s59, s57, 2
    s_lshr_b32 s98, s22, 7
    s_sub_u32 s59, s59, s98
    s_add_u32 s59, s59, 4
    s_and_b32 s59, s59, 7
    s_and_b32 s61, s60, 1
    s_lshr_b32 s62, s60, 1
    s_lshl_b32 s65, s58, 2
    s_lshl_b32 s66, s61, 1
    s_add_u32 s65, s65, s66
    s_lshr_b32 s66, s62, 1
    s_add_u32 s65, s65, s66
    s_xor_b32 s66, s65, 1
    s_mul_i32 s67, s62, 14
    s_mul_i32 s68, s65, 56
    s_mul_i32 s69, s66, 56
    s_add_u32 s68, s68, s67
    s_add_u32 s69, s69, s67
    s_lshl_b32 s68, s68, 10
    s_lshl_b32 s69, s69, 10
    s_and_b32 s70, s62, 1
    s_add_u32 s36, s28, 8388608
    s_addc_u32 s37, s29, 0
    s_mov_b32 s38, 24117248
    s_mov_b32 s39, 0x00020000
    s_and_b32 s98, s65, 1
    s_lshl1_add_u32 s98, s62, s98
    s_lshl_b32 s98, s98, 7
    s_add_u32 s98, s98, 16776832
    v_lshrrev_b32 v3, 3, v2
    v_cmp_eq_u32 vcc, 3, v3
    v_add_u32 v253, s98, v14
    v_xor_b32 v254, 0x80, v253
    v_cndmask_b32 v253, v14, v253, vcc
    v_cndmask_b32 v254, v14, v254, vcc
    s_add_u32 s40, s28, 5242880
    s_addc_u32 s41, s29, 0
    s_mov_b32 s42, 2097152
    s_mov_b32 s43, 0x00020000
    s_mov_b32 s44, s24
    s_mov_b32 s45, s25
    s_mov_b32 s46, 2097152
    s_mov_b32 s47, 0x00020000
    v_lshrrev_b32 v3, 1, v2
    s_and_b32 s71, s65, 7
    v_xor_b32 v12, s71, v3
    v_and_b32 v12, 7, v12
    v_lshlrev_b32 v12, 5, v12
    v_lshl_add_u32 v12, v3, 8, v12
    v_and_b32 v3, 1, v2
    v_lshl_add_u32 v20, v3, 4, v12
    s_lshr_b32 s71, s65, 3
    s_lshl_b32 s71, s71, 17
    s_lshl_b32 s72, s59, 1
    s_add_u32 s72, s72, s70
    s_lshl_b32 s73, s72, 13
    s_add_u32 s71, s71, s73
    s_lshl_b32 s73, s60, 10
    v_lshl_add_u32 v21, v2, 3, s73
    s_lshl_b32 s74, s60, 11
    s_add_u32 s74, s74, 32768
    v_add_u32 v22, s74, v14
    v_and_b32 v3, 15, v2
    v_lshlrev_b32 v3, 10, v3
    v_bfe_u32 v12, v2, 4, 1
    v_lshl_add_u32 v3, v12, 5, v3
    v_lshrrev_b32 v12, 5, v2
    v_lshl_add_u32 v23, v12, 4, v3
    s_lshl_b32 s75, s65, 14
    s_lshl_b32 s72, s72, 6
    s_add_u32 s75, s75, s72
    s_cmp_lg_u32 s88, 0
    s_cbranch_scc1 L_nopoll_30
    s_lshr_b32 s76, s58, 1
    s_lshl_b32 s76, s76, 4
    s_mul_i32 s90, s76, 128
    v_and_b32 v250, 15, v0
    v_min_u32 v250, 13, v250
    v_mul_u32_u24 v250, 128, v250
L_poll_31:
    buffer_load_dword v251, v250, s[84:87], s90 offen offset:32 sc1
    s_sub_u32 s89, s89, 1
    s_cbranch_scc1 L_pollx_32
L_polly_33:
    s_waitcnt vmcnt(0)
    v_cmp_ne_u32 vcc, s100, v251
    s_cbranch_vccnz L_poll_31
L_pollx_32:
    s_max_i32 s89, s89, 0
L_nopoll_30:
    s_barrier
    buffer_load_dwordx4 v[104:107], v253, s[36:39], s68 offen offset:0 sc1
    buffer_load_dwordx4 v[108:111], v254, s[36:39], s69 offen offset:0 sc1
    buffer_load_dwordx4 v[112:115], v253, s[36:39], s68 offen offset:1024 sc1
    buffer_load_dwordx4 v[116:119], v254, s[36:39], s69 offen offset:1024 sc1
    buffer_load_dwordx4 v[120:123], v253, s[36:39], s68 offen offset:2048 sc1
    buffer_load_dwordx4 v[124:127], v254, s[36:39], s69 offen offset:2048 sc1
    buffer_load_dwordx4 v[128:131], v253, s[36:39], s68 offen offset:3072 sc1
    buffer_load_dwordx4 v[132:135], v254, s[36:39], s69 offen offset:3072 sc1
    s_add_u32 s68, s68, 4096
    s_add_u32 s69, s69, 4096
    s_waitcnt vmcnt(6) lgkmcnt(0)
    v_mfma_f32_16x16x32_bf16 v[24:27], v[216:219], v[104:107], 0
    buffer_load_dwordx4 v[136:139], v253, s[36:39], s68 offen offset:0 sc1
    buffer_load_dwordx4 v[140:143], v254, s[36:39], s69 offen offset:0 sc1
    v_mfma_f32_16x16x32_bf16 v[40:43], v[216:219], v[108:111], 0
    v_mfma_f32_16x16x32_bf16 v[28:31], v[220:223], v[104:107], 0
    v_mfma_f32_16x16x32_bf16 v[44:47], v[220:223], v[108:111], 0
    v_mfma_f32_16x16x32_bf16 v[32:35], v[224:227], v[104:107], 0
    v_mfma_f32_16x16x32_bf16 v[48:51], v[224:227], v[108:111], 0
    v_mfma_f32_16x16x32_bf16 v[36:39], v[228:231], v[104:107], 0
    v_mfma_f32_16x16x32_bf16 v[52:55], v[228:231], v[108:111], 0
    s_waitcnt vmcnt(6) lgkmcnt(0)
    v_mfma_f32_16x16x32_bf16 v[24:27], v[232:235], v[112:115], v[24:27]
    buffer_load_dwordx4 v[144:147], v253, s[36:39], s68 offen offset:1024 sc1
    buffer_load_dwordx4 v[148:151], v254, s[36:39], s69 offen offset:1024 sc1
    v_mfma_f32_16x16x32_bf16 v[40:43], v[232:235], v[116:119], v[40:43]
    v_mfma_f32_16x16x32_bf16 v[28:31], v[236:239], v[112:115], v[28:31]
    v_mfma_f32_16x16x32_bf16 v[44:47], v[236:239], v[116:119], v[44:47]
    v_mfma_f32_16x16x32_bf16 v[32:35], v[240:243], v[112:115], v[32:35]
    v_mfma_f32_16x16x32_bf16 v[48:51], v[240:243], v[116:119], v[48:51]
    v_mfma_f32_16x16x32_bf16 v[36:39], v[244:247], v[112:115], v[36:39]
    v_mfma_f32_16x16x32_bf16 v[52:55], v[244:247], v[116:119], v[52:55]
    s_waitcnt vmcnt(6) lgkmcnt(0)
    v_mfma_f32_16x16x32_bf16 v[24:27], v[200:203], v[120:123], v[24:27]
    buffer_load_dwordx4 v[152:155], v253, s[36:39], s68 offen offset:2048 sc1
    buffer_load_dwordx4 v[156:159], v254, s[36:39], s69 offen offset:2048 sc1
    v_mfma_f32_16x16x32_bf16 v[40:43], v[200:203], v[124:127], v[40:43]
    v_mfma_f32_16x16x32_bf16 v[28:31], v[204:207], v[120:123], v[28:31]
    v_mfma_f32_16x16x32_bf16 v[44:47], v[204:207], v[124:127], v[44:47]
    v_mfma_f32_16x16x32_bf16 v[32:35], v[208:211], v[120:123], v[32:35]
    v_mfma_f32_16x16x32_bf16 v[48:51], v[208:211], v[124:127], v[48:51]
    v_mfma_f32_16x16x32_bf16 v[36:39], v[212:215], v[120:123], v[36:39]
    v_mfma_f32_16x16x32_bf16 v[52:55], v[212:215], v[124:127], v[52:55]
    s_waitcnt vmcnt(6) lgkmcnt(0)
    v_mfma_f32_16x16x32_bf16 v[24:27], v[56:59], v[128:131], v[24:27]
    buffer_load_dwordx4 v[160:163], v253, s[36:39], s68 offen offset:3072 sc1
    buffer_load_dwordx4 v[164:167], v254, s[36:39], s69 offen offset:3072 sc1
    s_add_u32 s68, s68, 4096
    s_add_u32 s69, s69, 4096
    v_mfma_f32_16x16x32_bf16 v[40:43], v[56:59], v[132:135], v[40:43]
    ds_read_b64_tr_b16 v[72:73], v4 offset:32768
    ds_read_b64_tr_b16 v[74:75], v4 offset:34816
    v_mfma_f32_16x16x32_bf16 v[28:31], v[60:63], v[128:131], v[28:31]
    ds_read_b64_tr_b16 v[76:77], v5 offset:32768
    ds_read_b64_tr_b16 v[78:79], v5 offset:34816
    v_mfma_f32_16x16x32_bf16 v[44:47], v[60:63], v[132:135], v[44:47]
    ds_read_b64_tr_b16 v[80:81], v6 offset:32768
    ds_read_b64_tr_b16 v[82:83], v6 offset:34816
    v_mfma_f32_16x16x32_bf16 v[32:35], v[64:67], v[128:131], v[32:35]
    ds_read_b64_tr_b16 v[84:85], v7 offset:32768
    ds_read_b64_tr_b16 v[86:87], v7 offset:34816
    v_mfma_f32_16x16x32_bf16 v[48:51], v[64:67], v[132:135], v[48:51]
    v_mfma_f32_16x16x32_bf16 v[36:39], v[68:71], v[128:131], v[36:39]
    v_mfma_f32_16x16x32_bf16 v[52:55], v[68:71], v[132:135], v[52:55]
    s_waitcnt vmcnt(6) lgkmcnt(0)
    v_mfma_f32_16x16x32_bf16 v[24:27], v[72:75], v[136:139], v[24:27]
    buffer_load_dwordx4 v[168:171], v253, s[36:39], s68 offen offset:0 sc1
    buffer_load_dwordx4 v[172:175], v254, s[36:39], s69 offen offset:0 sc1
    v_mfma_f32_16x16x32_bf16 v[40:43], v[72:75], v[140:143], v[40:43]
    ds_read_b64_tr_b16 v[88:89], v4 offset:40960
    ds_read_b64_tr_b16 v[90:91], v4 offset:43008
    v_mfma_f32_16x16x32_bf16 v[28:31], v[76:79], v[136:139], v[28:31]
    ds_read_b64_tr_b16 v[92:93], v5 offset:40960
    ds_read_b64_tr_b16 v[94:95], v5 offset:43008
    v_mfma_f32_16x16x32_bf16 v[44:47], v[76:79], v[140:143], v[44:47]
    ds_read_b64_tr_b16 v[96:97], v6 offset:40960
    ds_read_b64_tr_b16 v[98:99], v6 offset:43008
    v_mfma_f32_16x16x32_bf16 v[32:35], v[80:83], v[136:139], v[32:35]
    ds_read_b64_tr_b16 v[100:101], v7 offset:40960
    ds_read_b64_tr_b16 v[102:103], v7 offset:43008
    v_mfma_f32_16x16x32_bf16 v[48:51], v[80:83], v[140:143], v[48:51]
    v_mfma_f32_16x16x32_bf16 v[36:39], v[84:87], v[136:139], v[36:39]
    v_mfma_f32_16x16x32_bf16 v[52:55], v[84:87], v[140:143], v[52:55]
    s_waitcnt vmcnt(6) lgkmcnt(0)
    v_mfma_f32_16x16x32_bf16 v[24:27], v[88:91], v[144:147], v[24:27]
    buffer_load_dwordx4 v[176:179], v253, s[36:39], s68 offen offset:1024 sc1
    buffer_load_dwordx4 v[180:183], v254, s[36:39], s69 offen offset:1024 sc1
    v_mfma_f32_16x16x32_bf16 v[40:43], v[88:91], v[148:151], v[40:43]
    ds_read_b64_tr_b16 v[72:73], v8 offset:32768
    ds_read_b64_tr_b16 v[74:75], v8 offset:34816
    v_mfma_f32_16x16x32_bf16 v[28:31], v[92:95], v[144:147], v[28:31]
    ds_read_b64_tr_b16 v[76:77], v9 offset:32768
    ds_read_b64_tr_b16 v[78:79], v9 offset:34816
    v_mfma_f32_16x16x32_bf16 v[44:47], v[92:95], v[148:151], v[44:47]
    ds_read_b64_tr_b16 v[80:81], v10 offset:32768
    ds_read_b64_tr_b16 v[82:83], v10 offset:34816
    v_mfma_f32_16x16x32_bf16 v[32:35], v[96:99], v[144:147], v[32:35]
    ds_read_b64_tr_b16 v[84:85], v11 offset:32768
    ds_read_b64_tr_b16 v[86:87], v11 offset:34816
    v_mfma_f32_16x16x32_bf16 v[48:51], v[96:99], v[148:151], v[48:51]
    v_mfma_f32_16x16x32_bf16 v[36:39], v[100:103], v[144:147], v[36:39]
    v_mfma_f32_16x16x32_bf16 v[52:55], v[100:103], v[148:151], v[52:55]
    s_waitcnt vmcnt(6) lgkmcnt(0)
    v_mfma_f32_16x16x32_bf16 v[24:27], v[72:75], v[152:155], v[24:27]
    buffer_load_dwordx4 v[184:187], v253, s[36:39], s68 offen offset:2048 sc1
    buffer_load_dwordx4 v[188:191], v254, s[36:39], s69 offen offset:2048 sc1
    v_mfma_f32_16x16x32_bf16 v[40:43], v[72:75], v[156:159], v[40:43]
    ds_read_b64_tr_b16 v[88:89], v4 offset:0
    ds_read_b64_tr_b16 v[90:91], v4 offset:2048
    v_mfma_f32_16x16x32_bf16 v[28:31], v[76:79], v[152:155], v[28:31]
    ds_read_b64_tr_b16 v[92:93], v5 offset:0
    ds_read_b64_tr_b16 v[94:95], v5 offset:2048
    v_mfma_f32_16x16x32_bf16 v[44:47], v[76:79], v[156:159], v[44:47]
    ds_read_b64_tr_b16 v[96:97], v6 offset:0
    ds_read_b64_tr_b16 v[98:99], v6 offset:2048
    v_mfma_f32_16x16x32_bf16 v[32:35], v[80:83], v[152:155], v[32:35]
    ds_read_b64_tr_b16 v[100:101], v7 offset:0
    ds_read_b64_tr_b16 v[102:103], v7 offset:2048
    v_mfma_f32_16x16x32_bf16 v[48:51], v[80:83], v[156:159], v[48:51]
    v_mfma_f32_16x16x32_bf16 v[36:39], v[84:87], v[152:155], v[36:39]
    v_mfma_f32_16x16x32_bf16 v[52:55], v[84:87], v[156:159], v[52:55]
    s_waitcnt vmcnt(6) lgkmcnt(0)
    s_barrier
    v_mfma_f32_16x16x32_bf16 v[24:27], v[88:91], v[160:163], v[24:27]
    buffer_load_dwordx4 v[192:195], v253, s[36:39], s68 offen offset:3072 sc1
    buffer_load_dwordx4 v[196:199], v254, s[36:39], s69 offen offset:3072 sc1
    s_add_u32 s68, s68, 4096
    s_add_u32 s69, s69, 4096
    v_mfma_f32_16x16x32_bf16 v[40:43], v[88:91], v[164:167], v[40:43]
    s_mov_b32 m0, s73
    s_nop 0
    buffer_load_dwordx4 v20, s[40:43], s71 offen sc1 lds
    ds_read_b64_tr_b16 v[72:73], v4 offset:8192
    v_mfma_f32_16x16x32_bf16 v[28:31], v[92:95], v[160:163], v[28:31]
    ds_read_b64_tr_b16 v[74:75], v4 offset:10240
    ds_read_b64_tr_b16 v[76:77], v5 offset:8192
    v_mfma_f32_16x16x32_bf16 v[44:47], v[92:95], v[164:167], v[44:47]
    ds_read_b64_tr_b16 v[78:79], v5 offset:10240
    ds_read_b64_tr_b16 v[80:81], v6 offset:8192
    v_mfma_f32_16x16x32_bf16 v[32:35], v[96:99], v[160:163], v[32:35]
    ds_read_b64_tr_b16 v[82:83], v6 offset:10240
    ds_read_b64_tr_b16 v[84:85], v7 offset:8192
    v_mfma_f32_16x16x32_bf16 v[48:51], v[96:99], v[164:167], v[48:51]
    ds_read_b64_tr_b16 v[86:87], v7 offset:10240
    v_mfma_f32_16x16x32_bf16 v[36:39], v[100:103], v[160:163], v[36:39]
    v_mfma_f32_16x16x32_bf16 v[52:55], v[100:103], v[164:167], v[52:55]
    s_waitcnt vmcnt(7) lgkmcnt(0)
    v_mfma_f32_16x16x32_bf16 v[24:27], v[72:75], v[168:171], v[24:27]
    buffer_load_dwordx4 v[104:107], v253, s[36:39], s68 offen offset:0 sc1
    buffer_load_dwordx4 v[108:111], v254, s[36:39], s69 offen offset:0 sc1
    v_mfma_f32_16x16x32_bf16 v[40:43], v[72:75], v[172:175], v[40:43]
    ds_read_b64_tr_b16 v[88:89], v8 offset:0
    ds_read_b64_tr_b16 v[90:91], v8 offset:2048
    v_mfma_f32_16x16x32_bf16 v[28:31], v[76:79], v[168:171], v[28:31]
    ds_read_b64_tr_b16 v[92:93], v9 offset:0
    ds_read_b64_tr_b16 v[94:95], v9 offset:2048
    v_mfma_f32_16x16x32_bf16 v[44:47], v[76:79], v[172:175], v[44:47]
    ds_read_b64_tr_b16 v[96:97], v10 offset:0
    ds_read_b64_tr_b16 v[98:99], v10 offset:2048
    v_mfma_f32_16x16x32_bf16 v[32:35], v[80:83], v[168:171], v[32:35]
    ds_read_b64_tr_b16 v[100:101], v11 offset:0
    ds_read_b64_tr_b16 v[102:103], v11 offset:2048
    v_mfma_f32_16x16x32_bf16 v[48:51], v[80:83], v[172:175], v[48:51]
    v_mfma_f32_16x16x32_bf16 v[36:39], v[84:87], v[168:171], v[36:39]
    v_mfma_f32_16x16x32_bf16 v[52:55], v[84:87], v[172:175], v[52:55]
    s_waitcnt vmcnt(7) lgkmcnt(0)
    v_mfma_f32_16x16x32_bf16 v[24:27], v[88:91], v[176:179], v[24:27]
    buffer_load_dwordx4 v[112:115], v253, s[36:39], s68 offen offset:1024 sc1
    buffer_load_dwordx4 v[116:119], v254, s[36:39], s69 offen offset:1024 sc1
    v_mfma_f32_16x16x32_bf16 v[40:43], v[88:91], v[180:183], v[40:43]
    ds_read_b64_tr_b16 v[72:73], v4 offset:16384
    ds_read_b64_tr_b16 v[74:75], v4 offset:18432
    v_mfma_f32_16x16x32_bf16 v[28:31], v[92:95], v[176:179], v[28:31]
    ds_read_b64_tr_b16 v[76:77], v5 offset:16384
    ds_read_b64_tr_b16 v[78:79], v5 offset:18432
    v_mfma_f32_16x16x32_bf16 v[44:47], v[92:95], v[180:183], v[44:47]
    ds_read_b64_tr_b16 v[80:81], v6 offset:16384
    ds_read_b64_tr_b16 v[82:83], v6 offset:18432
    v_mfma_f32_16x16x32_bf16 v[32:35], v[96:99], v[176:179], v[32:35]
    ds_read_b64_tr_b16 v[84:85], v7 offset:16384
    ds_read_b64_tr_b16 v[86:87], v7 offset:18432
    v_mfma_f32_16x16x32_bf16 v[48:51], v[96:99], v[180:183], v[48:51]
    v_mfma_f32_16x16x32_bf16 v[36:39], v[100:103], v[176:179], v[36:39]
    v_mfma_f32_16x16x32_bf16 v[52:55], v[100:103], v[180:183], v[52:55]
    s_waitcnt vmcnt(7) lgkmcnt(0)
    v_mfma_f32_16x16x32_bf16 v[24:27], v[72:75], v[184:187], v[24:27]
    ds_read_b64_tr_b16 v[88:89], v4 offset:24576
    ds_read_b64_tr_b16 v[90:91], v4 offset:26624
    v_mfma_f32_16x16x32_bf16 v[40:43], v[72:75], v[188:191], v[40:43]
    ds_read_b64_tr_b16 v[92:93], v5 offset:24576
    ds_read_b64_tr_b16 v[94:95], v5 offset:26624
    v_mfma_f32_16x16x32_bf16 v[28:31], v[76:79], v[184:187], v[28:31]
    ds_read_b64_tr_b16 v[96:97], v6 offset:24576
    ds_read_b64_tr_b16 v[98:99], v6 offset:26624
    v_mfma_f32_16x16x32_bf16 v[44:47], v[76:79], v[188:191], v[44:47]
    ds_read_b64_tr_b16 v[100:101], v7 offset:24576
    ds_read_b64_tr_b16 v[102:103], v7 offset:26624
    v_mfma_f32_16x16x32_bf16 v[32:35], v[80:83], v[184:187], v[32:35]
    v_mfma_f32_16x16x32_bf16 v[48:51], v[80:83], v[188:191], v[48:51]
    v_mfma_f32_16x16x32_bf16 v[36:39], v[84:87], v[184:187], v[36:39]
    v_mfma_f32_16x16x32_bf16 v[52:55], v[84:87], v[188:191], v[52:55]
    s_waitcnt vmcnt(5) lgkmcnt(0)
    v_mfma_f32_16x16x32_bf16 v[24:27], v[88:91], v[192:195], v[24:27]
    ds_read_b64_tr_b16 v[72:73], v8 offset:16384
    ds_read_b64_tr_b16 v[74:75], v8 offset:18432
    v_mfma_f32_16x16x32_bf16 v[40:43], v[88:91], v[196:199], v[40:43]
    ds_read_b64_tr_b16 v[76:77], v9 offset:16384
    ds_read_b64_tr_b16 v[78:79], v9 offset:18432
    v_mfma_f32_16x16x32_bf16 v[28:31], v[92:95], v[192:195], v[28:31]
    ds_read_b64_tr_b16 v[80:81], v10 offset:16384
    ds_read_b64_tr_b16 v[82:83], v10 offset:18432
    v_mfma_f32_16x16x32_bf16 v[44:47], v[92:95], v[196:199], v[44:47]
    ds_read_b64_tr_b16 v[84:85], v11 offset:16384
    ds_read_b64_tr_b16 v[86:87], v11 offset:18432
    v_mfma_f32_16x16x32_bf16 v[32:35], v[96:99], v[192:195], v[32:35]
    v_mfma_f32_16x16x32_bf16 v[48:51], v[96:99], v[196:199], v[48:51]
    v_mfma_f32_16x16x32_bf16 v[36:39], v[100:103], v[192:195], v[36:39]
    v_mfma_f32_16x16x32_bf16 v[52:55], v[100:103], v[196:199], v[52:55]
    s_waitcnt vmcnt(2) lgkmcnt(0)
    v_mfma_f32_16x16x32_bf16 v[24:27], v[72:75], v[104:107], v[24:27]
    ds_read_b64_tr_b16 v[88:89], v8 offset:49152
    ds_read_b64_tr_b16 v[90:91], v8 offset:51200
    v_mfma_f32_16x16x32_bf16 v[40:43], v[72:75], v[108:111], v[40:43]
    ds_read_b64_tr_b16 v[92:93], v9 offset:49152
    ds_read_b64_tr_b16 v[94:95], v9 offset:51200
    v_mfma_f32_16x16x32_bf16 v[28:31], v[76:79], v[104:107], v[28:31]
    ds_read_b64_tr_b16 v[96:97], v10 offset:49152
    ds_read_b64_tr_b16 v[98:99], v10 offset:51200
    v_mfma_f32_16x16x32_bf16 v[44:47], v[76:79], v[108:111], v[44:47]
    ds_read_b64_tr_b16 v[100:101], v11 offset:49152
    ds_read_b64_tr_b16 v[102:103], v11 offset:51200
    v_mfma_f32_16x16x32_bf16 v[32:35], v[80:83], v[104:107], v[32:35]
    v_mfma_f32_16x16x32_bf16 v[48:51], v[80:83], v[108:111], v[48:51]
    v_mfma_f32_16x16x32_bf16 v[36:39], v[84:87], v[104:107], v[36:39]
    v_mfma_f32_16x16x32_bf16 v[52:55], v[84:87], v[108:111], v[52:55]
    s_waitcnt vmcnt(0) lgkmcnt(0)
    v_mfma_f32_16x16x32_bf16 v[48:51], v[96:99], v[116:119], v[48:51]
    ds_read_b64_tr_b16 v[56:57], v21
    v_mfma_f32_16x16x32_bf16 v[52:55], v[100:103], v[116:119], v[52:55]
    ds_read_b64_tr_b16 v[58:59], v21 offset:512
    v_mfma_f32_16x16x32_bf16 v[40:43], v[88:91], v[116:119], v[40:43]
    s_xor_b32 s76, s60, 2
    s_lshl_b32 s76, s76, 11
    s_add_u32 s76, s76, 32768
    v_add_u32 v5, s76, v14
    v_mfma_f32_16x16x32_bf16 v[44:47], v[92:95], v[116:119], v[44:47]
    s_xor_b32 s76, s60, 4
    s_lshl_b32 s76, s76, 11
    s_add_u32 s76, s76, 81920
    v_add_u32 v6, s76, v14
    v_mfma_f32_16x16x32_bf16 v[32:35], v[96:99], v[112:115], v[32:35]
    s_xor_b32 s76, s60, 6
    s_lshl_b32 s76, s76, 11
    s_add_u32 s76, s76, 131072
    v_add_u32 v7, s76, v14
    v_mfma_f32_16x16x32_bf16 v[36:39], v[100:103], v[112:115], v[36:39]
    v_mfma_f32_16x16x32_bf16 v[24:27], v[88:91], v[112:115], v[24:27]
    v_mfma_f32_16x16x32_bf16 v[28:31], v[92:95], v[112:115], v[28:31]
    s_nop 1
    ds_write_b128 v7, v[48:51]
    ds_write_b128 v7, v[52:55] offset:1024
    ds_write_b128 v6, v[40:43]
    ds_write_b128 v6, v[44:47] offset:1024
    s_nop 3
    ds_write_b128 v5, v[32:35]
    ds_write_b128 v5, v[36:39] offset:1024
    s_mov_b32 s70, 0xffff0000
    v_add_u32 v12, 98304, v22
    s_waitcnt lgkmcnt(6)
    v_lshlrev_b32 v64, 16, v56
    v_and_b32 v65, s70, v56
    v_lshlrev_b32 v66, 16, v57
    v_and_b32 v67, s70, v57
    v_lshlrev_b32 v68, 16, v58
    v_and_b32 v69, s70, v58
    v_lshlrev_b32 v70, 16, v59
    v_and_b32 v71, s70, v59
    s_waitcnt lgkmcnt(0)
    s_barrier
    ds_read_b128 v[104:107], v22 offset:0
    ds_read_b128 v[108:111], v22 offset:1024
    ds_read_b128 v[112:115], v22 offset:49152
    ds_read_b128 v[116:119], v22 offset:50176
    ds_read_b128 v[120:123], v12 offset:0
    ds_read_b128 v[124:127], v12 offset:1024
    s_waitcnt lgkmcnt(4)
    v_pk_add_f32 v[24:25], v[24:25], v[104:105]
    v_pk_add_f32 v[26:27], v[26:27], v[106:107]
    v_pk_add_f32 v[28:29], v[28:29], v[108:109]
    v_pk_add_f32 v[30:31], v[30:31], v[110:111]
    s_waitcnt lgkmcnt(2)
    v_pk_add_f32 v[24:25], v[24:25], v[112:113]
    v_pk_add_f32 v[26:27], v[26:27], v[114:115]
    v_pk_add_f32 v[28:29], v[28:29], v[116:117]
    v_pk_add_f32 v[30:31], v[30:31], v[118:119]
    s_waitcnt lgkmcnt(0)
    v_pk_add_f32 v[24:25], v[24:25], v[120:121]
    v_pk_add_f32 v[26:27], v[26:27], v[122:123]
    v_pk_add_f32 v[28:29], v[28:29], v[124:125]
    v_pk_add_f32 v[30:31], v[30:31], v[126:127]
    v_cvt_pk_bf16_f32 v56, v24, v25
    v_cvt_pk_bf16_f32 v57, v26, v27
    v_cvt_pk_bf16_f32 v58, v28, v29
    v_cvt_pk_bf16_f32 v59, v30, v31
    v_lshlrev_b32 v24, 16, v56
    v_and_b32 v25, s70, v56
    v_lshlrev_b32 v26, 16, v57
    v_and_b32 v27, s70, v57
    v_lshlrev_b32 v28, 16, v58
    v_and_b32 v29, s70, v58
    v_lshlrev_b32 v30, 16, v59
    v_and_b32 v31, s70, v59
    v_pk_add_f32 v[24:25], v[24:25], v[64:65]
    v_pk_add_f32 v[26:27], v[26:27], v[66:67]
    v_pk_add_f32 v[28:29], v[28:29], v[68:69]
    v_pk_add_f32 v[30:31], v[30:31], v[70:71]
    v_cvt_pk_bf16_f32 v56, v24, v25
    v_cvt_pk_bf16_f32 v57, v26, v27
    v_cvt_pk_bf16_f32 v58, v28, v29
    v_cvt_pk_bf16_f32 v59, v30, v31
    s_nop 1
    v_permlane16_swap_b32 v56, v58
    v_permlane16_swap_b32 v57, v59
    buffer_store_dwordx4 v[56:59], v23, s[44:47], s75 offen
L_end:
    s_endpgm
L_spare:
    s_cmp_ge_u32 s57, 30
    s_cbranch_scc1 L_csj_35
    s_and_b32 s61, s2, 3
    s_lshl_b32 s61, s61, 2
    s_bfe_u32 s62, s2, 0x10002
    s_lshl_b32 s62, s62, 1
    s_add_u32 s61, s61, s62
    s_add_u32 s61, s61, s57
    s_sub_u32 s61, s61, 28
    s_lshl_b32 s62, s61, 17
    s_add_u32 s62, s62, 5242880
    s_add_u32 s32, s28, s62
    s_addc_u32 s33, s29, 0
    s_mov_b32 s34, 131072
    s_mov_b32 s35, 0x00020000
    s_add_u32 m0, s63, 0
    s_mov_b32 s64, 0
    buffer_load_dwordx4 v12, s[32:35], s64 offen sc1 lds
    s_add_u32 m0, s63, 8192
    s_mov_b32 s64, 8192
    buffer_load_dwordx4 v12, s[32:35], s64 offen sc1 lds
    s_add_u32 m0, s63, 16384
    s_mov_b32 s64, 16384
    buffer_load_dwordx4 v12, s[32:35], s64 offen sc1 lds
    s_add_u32 m0, s63, 24576
    s_mov_b32 s64, 24576
    buffer_load_dwordx4 v12, s[32:35], s64 offen sc1 lds
    s_add_u32 m0, s63, 32768
    s_mov_b32 s64, 32768
    buffer_load_dwordx4 v12, s[32:35], s64 offen sc1 lds
    s_add_u32 m0, s63, 40960
    s_mov_b32 s64, 40960
    buffer_load_dwordx4 v12, s[32:35], s64 offen sc1 lds
    s_add_u32 m0, s63, 49152
    s_mov_b32 s64, 49152
    buffer_load_dwordx4 v12, s[32:35], s64 offen sc1 lds
    s_add_u32 m0, s63, 57344
    s_mov_b32 s64, 57344
    buffer_load_dwordx4 v12, s[32:35], s64 offen sc1 lds
    s_add_u32 m0, s63, 65536
    s_mov_b32 s64, 65536
    buffer_load_dwordx4 v12, s[32:35], s64 offen sc1 lds
    s_add_u32 m0, s63, 73728
    s_mov_b32 s64, 73728
    buffer_load_dwordx4 v12, s[32:35], s64 offen sc1 lds
    s_add_u32 m0, s63, 81920
    s_mov_b32 s64, 81920
    buffer_load_dwordx4 v12, s[32:35], s64 offen sc1 lds
    s_add_u32 m0, s63, 90112
    s_mov_b32 s64, 90112
    buffer_load_dwordx4 v12, s[32:35], s64 offen sc1 lds
    s_add_u32 m0, s63, 98304
    s_mov_b32 s64, 98304
    buffer_load_dwordx4 v12, s[32:35], s64 offen sc1 lds
    s_add_u32 m0, s63, 106496
    s_mov_b32 s64, 106496
    buffer_load_dwordx4 v12, s[32:35], s64 offen sc1 lds
    s_add_u32 m0, s63, 114688
    s_mov_b32 s64, 114688
    buffer_load_dwordx4 v12, s[32:35], s64 offen sc1 lds
    s_add_u32 m0, s63, 122880
    s_mov_b32 s64, 122880
    buffer_load_dwordx4 v12, s[32:35], s64 offen sc1 lds
    s_xor_b32 s62, s68, s88
    s_lshl_b32 s62, s62, 5
    v_xor_b32 v4, s62, v4
    v_subrev_u32 v4, 98304, v4
    v_add_u32 v5, 0x10000, v4
    v_mov_b32 v16, 0
    v_mov_b32 v17, 0
    v_mov_b32 v20, 0x3f803f80
    s_lshl_b32 s62, s61, 9
    s_lshl_b32 s64, s88, 6
    s_add_u32 s62, s62, s64
    s_add_u32 s62, s62, 16384
    v_lshlrev_b32 v7, 2, v2
    v_and_b32 v8, 0x30, v2
    v_lshl_add_u32 v7, v8, 12, v7
    s_waitcnt vmcnt(8)
    s_barrier
    ds_read_b64_tr_b16 v[40:41], v4 offset:0
    ds_read_b64_tr_b16 v[42:43], v4 offset:4096
    ds_read_b64_tr_b16 v[44:45], v4 offset:8192
    ds_read_b64_tr_b16 v[46:47], v4 offset:12288
    ds_read_b64_tr_b16 v[48:49], v4 offset:16384
    ds_read_b64_tr_b16 v[50:51], v4 offset:20480
    ds_read_b64_tr_b16 v[52:53], v4 offset:24576
    ds_read_b64_tr_b16 v[54:55], v4 offset:28672
    ds_read_b64_tr_b16 v[56:57], v4 offset:32768
    ds_read_b64_tr_b16 v[58:59], v4 offset:36864
    ds_read_b64_tr_b16 v[60:61], v4 offset:40960
    ds_read_b64_tr_b16 v[62:63], v4 offset:45056
    ds_read_b64_tr_b16 v[64:65], v4 offset:49152
    ds_read_b64_tr_b16 v[66:67], v4 offset:53248
    ds_read_b64_tr_b16 v[68:69], v4 offset:57344
    ds_read_b64_tr_b16 v[70:71], v4 offset:61440
    s_waitcnt lgkmcnt(12)
    v_dot2c_f32_bf16 v16, v40, v20
    v_dot2c_f32_bf16 v17, v40, v40
    v_dot2c_f32_bf16 v16, v41, v20
    v_dot2c_f32_bf16 v17, v41, v41
    v_dot2c_f32_bf16 v16, v42, v20
    v_dot2c_f32_bf16 v17, v42, v42
    v_dot2c_f32_bf16 v16, v43, v20
    v_dot2c_f32_bf16 v17, v43, v43
    v_dot2c_f32_bf16 v16, v44, v20
    v_dot2c_f32_bf16 v17, v44, v44
    v_dot2c_f32_bf16 v16, v45, v20
    v_dot2c_f32_bf16 v17, v45, v45
    v_dot2c_f32_bf16 v16, v46, v20
    v_dot2c_f32_bf16 v17, v46, v46
    v_dot2c_f32_bf16 v16, v47, v20
    v_dot2c_f32_bf16 v17, v47, v47
    s_waitcnt lgkmcnt(8)
    v_dot2c_f32_bf16 v16, v48, v20
    v_dot2c_f32_bf16 v17, v48, v48
    v_dot2c_f32_bf16 v16, v49, v20
    v_dot2c_f32_bf16 v17, v49, v49
    v_dot2c_f32_bf16 v16, v50, v20
    v_dot2c_f32_bf16 v17, v50, v50
    v_dot2c_f32_bf16 v16, v51, v20
    v_dot2c_f32_bf16 v17, v51, v51
    v_dot2c_f32_bf16 v16, v52, v20
    v_dot2c_f32_bf16 v17, v52, v52
    v_dot2c_f32_bf16 v16, v53, v20
    v_dot2c_f32_bf16 v17, v53, v53
    v_dot2c_f32_bf16 v16, v54, v20
    v_dot2c_f32_bf16 v17, v54, v54
    v_dot2c_f32_bf16 v16, v55, v20
    v_dot2c_f32_bf16 v17, v55, v55
    s_waitcnt lgkmcnt(4)
    v_dot2c_f32_bf16 v16, v56, v20
    v_dot2c_f32_bf16 v17, v56, v56
    v_dot2c_f32_bf16 v16, v57, v20
    v_dot2c_f32_bf16 v17, v57, v57
    v_dot2c_f32_bf16 v16, v58, v20
    v_dot2c_f32_bf16 v17, v58, v58
    v_dot2c_f32_bf16 v16, v59, v20
    v_dot2c_f32_bf16 v17, v59, v59
    v_dot2c_f32_bf16 v16, v60, v20
    v_dot2c_f32_bf16 v17, v60, v60
    v_dot2c_f32_bf16 v16, v61, v20
    v_dot2c_f32_bf16 v17, v61, v61
    v_dot2c_f32_bf16 v16, v62, v20
    v_dot2c_f32_bf16 v17, v62, v62
    v_dot2c_f32_bf16 v16, v63, v20
    v_dot2c_f32_bf16 v17, v63, v63
    s_waitcnt lgkmcnt(0)
    v_dot2c_f32_bf16 v16, v64, v20
    v_dot2c_f32_bf16 v17, v64, v64
    v_dot2c_f32_bf16 v16, v65, v20
    v_dot2c_f32_bf16 v17, v65, v65
    v_dot2c_f32_bf16 v16, v66, v20
    v_dot2c_f32_bf16 v17, v66, v66
    v_dot2c_f32_bf16 v16, v67, v20
    v_dot2c_f32_bf16 v17, v67, v67
    v_dot2c_f32_bf16 v16, v68, v20
    v_dot2c_f32_bf16 v17, v68, v68
    v_dot2c_f32_bf16 v16, v69, v20
    v_dot2c_f32_bf16 v17, v69, v69
    v_dot2c_f32_bf16 v16, v70, v20
    v_dot2c_f32_bf16 v17, v70, v70
    v_dot2c_f32_bf16 v16, v71, v20
    v_dot2c_f32_bf16 v17, v71, v71
    s_waitcnt vmcnt(0)
    s_barrier
    ds_read_b64_tr_b16 v[40:41], v5 offset:0
    ds_read_b64_tr_b16 v[42:43], v5 offset:4096
    ds_read_b64_tr_b16 v[44:45], v5 offset:8192
    ds_read_b64_tr_b16 v[46:47], v5 offset:12288
    ds_read_b64_tr_b16 v[48:49], v5 offset:16384
    ds_read_b64_tr_b16 v[50:51], v5 offset:20480
    ds_read_b64_tr_b16 v[52:53], v5 offset:24576
    ds_read_b64_tr_b16 v[54:55], v5 offset:28672
    ds_read_b64_tr_b16 v[56:57], v5 offset:32768
    ds_read_b64_tr_b16 v[58:59], v5 offset:36864
    ds_read_b64_tr_b16 v[60:61], v5 offset:40960
    ds_read_b64_tr_b16 v[62:63], v5 offset:45056
    ds_read_b64_tr_b16 v[64:65], v5 offset:49152
    ds_read_b64_tr_b16 v[66:67], v5 offset:53248
    ds_read_b64_tr_b16 v[68:69], v5 offset:57344
    ds_read_b64_tr_b16 v[70:71], v5 offset:61440
    s_waitcnt lgkmcnt(12)
    v_dot2c_f32_bf16 v16, v40, v20
    v_dot2c_f32_bf16 v17, v40, v40
    v_dot2c_f32_bf16 v16, v41, v20
    v_dot2c_f32_bf16 v17, v41, v41
    v_dot2c_f32_bf16 v16, v42, v20
    v_dot2c_f32_bf16 v17, v42, v42
    v_dot2c_f32_bf16 v16, v43, v20
    v_dot2c_f32_bf16 v17, v43, v43
    v_dot2c_f32_bf16 v16, v44, v20
    v_dot2c_f32_bf16 v17, v44, v44
    v_dot2c_f32_bf16 v16, v45, v20
    v_dot2c_f32_bf16 v17, v45, v45
    v_dot2c_f32_bf16 v16, v46, v20
    v_dot2c_f32_bf16 v17, v46, v46
    v_dot2c_f32_bf16 v16, v47, v20
    v_dot2c_f32_bf16 v17, v47, v47
    s_waitcnt lgkmcnt(8)
    v_dot2c_f32_bf16 v16, v48, v20
    v_dot2c_f32_bf16 v17, v48, v48
    v_dot2c_f32_bf16 v16, v49, v20
    v_dot2c_f32_bf16 v17, v49, v49
    v_dot2c_f32_bf16 v16, v50, v20
    v_dot2c_f32_bf16 v17, v50, v50
    v_dot2c_f32_bf16 v16, v51, v20
    v_dot2c_f32_bf16 v17, v51, v51
    v_dot2c_f32_bf16 v16, v52, v20
    v_dot2c_f32_bf16 v17, v52, v52
    v_dot2c_f32_bf16 v16, v53, v20
    v_dot2c_f32_bf16 v17, v53, v53
    v_dot2c_f32_bf16 v16, v54, v20
    v_dot2c_f32_bf16 v17, v54, v54
    v_dot2c_f32_bf16 v16, v55, v20
    v_dot2c_f32_bf16 v17, v55, v55
    s_waitcnt lgkmcnt(4)
    v_dot2c_f32_bf16 v16, v56, v20
    v_dot2c_f32_bf16 v17, v56, v56
    v_dot2c_f32_bf16 v16, v57, v20
    v_dot2c_f32_bf16 v17, v57, v57
    v_dot2c_f32_bf16 v16, v58, v20
    v_dot2c_f32_bf16 v17, v58, v58
    v_dot2c_f32_bf16 v16, v59, v20
    v_dot2c_f32_bf16 v17, v59, v59
    v_dot2c_f32_bf16 v16, v60, v20
    v_dot2c_f32_bf16 v17, v60, v60
    v_dot2c_f32_bf16 v16, v61, v20
    v_dot2c_f32_bf16 v17, v61, v61
    v_dot2c_f32_bf16 v16, v62, v20
    v_dot2c_f32_bf16 v17, v62, v62
    v_dot2c_f32_bf16 v16, v63, v20
    v_dot2c_f32_bf16 v17, v63, v63
    s_waitcnt lgkmcnt(0)
    v_dot2c_f32_bf16 v16, v64, v20
    v_dot2c_f32_bf16 v17, v64, v64
    v_dot2c_f32_bf16 v16, v65, v20
    v_dot2c_f32_bf16 v17, v65, v65
    v_dot2c_f32_bf16 v16, v66, v20
    v_dot2c_f32_bf16 v17, v66, v66
    v_dot2c_f32_bf16 v16, v67, v20
    v_dot2c_f32_bf16 v17, v67, v67
    v_dot2c_f32_bf16 v16, v68, v20
    v_dot2c_f32_bf16 v17, v68, v68
    v_dot2c_f32_bf16 v16, v69, v20
    v_dot2c_f32_bf16 v17, v69, v69
    v_dot2c_f32_bf16 v16, v70, v20
    v_dot2c_f32_bf16 v17, v70, v70
    v_dot2c_f32_bf16 v16, v71, v20
    v_dot2c_f32_bf16 v17, v71, v71
    s_nop 2
    v_mov_b32 v18, v16
    v_mov_b32 v19, v17
    s_nop 1
    v_permlane16_swap_b32 v16, v18
    v_permlane16_swap_b32 v17, v19
    v_add_f32 v16, v16, v18
    v_add_f32 v17, v17, v19
    v_mov_b32 v18, v16
    v_mov_b32 v19, v17
    s_nop 1
    v_permlane32_swap_b32 v16, v18
    v_permlane32_swap_b32 v17, v19
    v_add_f32 v16, v16, v18
    v_add_f32 v17, v17, v19
    v_mul_f32 v16, 0x3b000000, v16
    v_mul_f32 v17, 0x3b000000, v17
    v_fma_f32 v17, -v16, v16, v17
    v_max_f32 v17, 0, v17
    v_cvt_pk_bf16_f32 v19, v17, v17
    v_lshlrev_b32 v19, 16, v19
    v_add_f32 v19, 0x3727c5ac, v19
    v_cvt_pk_bf16_f32 v19, v19, v19
    v_lshlrev_b32 v19, 16, v19
    v_sqrt_f32 v19, v19
    s_nop 0
    v_cvt_pk_bf16_f32 v18, v16, v19
    buffer_store_dword v18, v7, s[48:51], s62 offen sc1
    s_add_u32 s72, s61, 32
    s_waitcnt vmcnt(0)
    s_barrier
    s_cmp_lg_u32 s88, 0
    s_cbranch_scc1 L_done_34
    v_mov_b32 v251, s100
    s_mul_i32 s90, s72, 128
    s_mov_b64 exec, 1
    buffer_store_dword v251, off, s[84:87], s90 offset:36 sc1
    s_mov_b64 exec, -1
    s_branch L_done_34
L_csj_35:
    s_and_b32 s61, s2, 3
    s_lshl_b32 s61, s61, 1
    s_add_u32 s61, s61, s57
    s_sub_u32 s61, s61, 30
    s_cmp_ge_u32 s61, 7
    s_cbranch_scc1 L_done_34
    s_bfe_u32 s72, s2, 0x10002
    s_mul_i32 s72, s72, 7
    s_add_u32 s72, s72, s61
    s_lshl_b32 s61, s72, 8
    s_mul_i32 s62, s88, 14336
    s_add_u32 s61, s61, s62
    v_lshrrev_b32 v3, 4, v2
    v_mul_u32_u24 v3, 3584, v3
    v_and_b32 v7, 15, v2
    v_lshl_add_u32 v3, v7, 4, v3
    s_add_u32 s62, s61, 688128
    buffer_load_dwordx4 v[88:91], v3, s[36:39], s62 offen
    buffer_load_dwordx4 v[92:95], v3, s[40:43], s62 offen
    s_add_u32 s62, s61, 802816
    buffer_load_dwordx4 v[96:99], v3, s[36:39], s62 offen
    buffer_load_dwordx4 v[100:103], v3, s[40:43], s62 offen
    s_add_u32 s62, s61, 917504
    buffer_load_dwordx4 v[104:107], v3, s[36:39], s62 offen
    buffer_load_dwordx4 v[108:111], v3, s[40:43], s62 offen
    s_add_u32 s62, s61, 1032192
    buffer_load_dwordx4 v[112:115], v3, s[36:39], s62 offen
    buffer_load_dwordx4 v[116:119], v3, s[40:43], s62 offen
    s_add_u32 s62, s61, 1146880
    buffer_load_dwordx4 v[120:123], v3, s[36:39], s62 offen
    buffer_load_dwordx4 v[124:127], v3, s[40:43], s62 offen
    s_add_u32 s62, s61, 1261568
    buffer_load_dwordx4 v[128:131], v3, s[36:39], s62 offen
    buffer_load_dwordx4 v[132:135], v3, s[40:43], s62 offen
    s_add_u32 s62, s61, 1376256
    buffer_load_dwordx4 v[136:139], v3, s[36:39], s62 offen
    buffer_load_dwordx4 v[140:143], v3, s[40:43], s62 offen
    s_add_u32 s62, s61, 1490944
    buffer_load_dwordx4 v[144:147], v3, s[36:39], s62 offen
    buffer_load_dwordx4 v[148:151], v3, s[40:43], s62 offen
    s_add_u32 s62, s61, 1605632
    buffer_load_dwordx4 v[152:155], v3, s[36:39], s62 offen
    buffer_load_dwordx4 v[156:159], v3, s[40:43], s62 offen
    s_add_u32 s62, s61, 1720320
    buffer_load_dwordx4 v[160:163], v3, s[36:39], s62 offen
    buffer_load_dwordx4 v[164:167], v3, s[40:43], s62 offen
    s_add_u32 s62, s61, 0
    buffer_load_dwordx4 v[40:43], v3, s[36:39], s62 offen
    buffer_load_dwordx4 v[44:47], v3, s[40:43], s62 offen
    s_add_u32 s62, s61, 114688
    buffer_load_dwordx4 v[48:51], v3, s[36:39], s62 offen
    buffer_load_dwordx4 v[52:55], v3, s[40:43], s62 offen
    s_add_u32 s62, s61, 229376
    buffer_load_dwordx4 v[56:59], v3, s[36:39], s62 offen
    buffer_load_dwordx4 v[60:63], v3, s[40:43], s62 offen
    s_add_u32 s62, s61, 344064
    buffer_load_dwordx4 v[64:67], v3, s[36:39], s62 offen
    buffer_load_dwordx4 v[68:71], v3, s[40:43], s62 offen
    s_add_u32 s62, s61, 458752
    buffer_load_dwordx4 v[72:75], v3, s[36:39], s62 offen
    buffer_load_dwordx4 v[76:79], v3, s[40:43], s62 offen
    s_add_u32 s62, s61, 573440
    buffer_load_dwordx4 v[80:83], v3, s[36:39], s62 offen
    buffer_load_dwordx4 v[84:87], v3, s[40:43], s62 offen
    v_mov_b32 v9, 0x3f80
    v_and_b32 v8, 1, v2
    v_lshlrev_b32 v8, 4, v8
    v_lshlrev_b32 v9, v8, v9
    v_bfe_u32 v8, v2, 1, 2
    v_cmp_eq_u32 vcc, 0, v8
    s_nop 1
    v_cndmask_b32 v16, 0, v9, vcc
    v_cmp_eq_u32 vcc, 1, v8
    s_nop 1
    v_cndmask_b32 v17, 0, v9, vcc
    v_cmp_eq_u32 vcc, 2, v8
    s_nop 1
    v_cndmask_b32 v18, 0, v9, vcc
    v_cmp_eq_u32 vcc, 3, v8
    s_nop 1
    v_cndmask_b32 v19, 0, v9, vcc
    v_lshlrev_b32 v7, 5, v7
    v_and_b32 v8, 16, v2
    v_add3_u32 v7, v7, v8, s63
    s_waitcnt vmcnt(30)
    v_mfma_f32_16x16x32_bf16 v[20:23], v[16:19], v[88:91], 0
    v_mfma_f32_16x16x32_bf16 v[24:27], v[16:19], v[92:95], 0
    s_waitcnt vmcnt(28)
    v_mfma_f32_16x16x32_bf16 v[20:23], v[16:19], v[96:99], v[20:23]
    v_mfma_f32_16x16x32_bf16 v[24:27], v[16:19], v[100:103], v[24:27]
    s_waitcnt vmcnt(26)
    v_mfma_f32_16x16x32_bf16 v[20:23], v[16:19], v[104:107], v[20:23]
    v_mfma_f32_16x16x32_bf16 v[24:27], v[16:19], v[108:111], v[24:27]
    s_waitcnt vmcnt(24)
    v_mfma_f32_16x16x32_bf16 v[20:23], v[16:19], v[112:115], v[20:23]
    v_mfma_f32_16x16x32_bf16 v[24:27], v[16:19], v[116:119], v[24:27]
    s_waitcnt vmcnt(22)
    v_mfma_f32_16x16x32_bf16 v[20:23], v[16:19], v[120:123], v[20:23]
    v_mfma_f32_16x16x32_bf16 v[24:27], v[16:19], v[124:127], v[24:27]
    s_waitcnt vmcnt(20)
    v_mfma_f32_16x16x32_bf16 v[20:23], v[16:19], v[128:131], v[20:23]
    v_mfma_f32_16x16x32_bf16 v[24:27], v[16:19], v[132:135], v[24:27]
    s_waitcnt vmcnt(18)
    v_mfma_f32_16x16x32_bf16 v[20:23], v[16:19], v[136:139], v[20:23]
    v_mfma_f32_16x16x32_bf16 v[24:27], v[16:19], v[140:143], v[24:27]
    s_waitcnt vmcnt(16)
    v_mfma_f32_16x16x32_bf16 v[20:23], v[16:19], v[144:147], v[20:23]
    v_mfma_f32_16x16x32_bf16 v[24:27], v[16:19], v[148:151], v[24:27]
    s_waitcnt vmcnt(14)
    v_mfma_f32_16x16x32_bf16 v[20:23], v[16:19], v[152:155], v[20:23]
    v_mfma_f32_16x16x32_bf16 v[24:27], v[16:19], v[156:159], v[24:27]
    s_waitcnt vmcnt(12)
    v_mfma_f32_16x16x32_bf16 v[20:23], v[16:19], v[160:163], v[20:23]
    v_mfma_f32_16x16x32_bf16 v[24:27], v[16:19], v[164:167], v[24:27]
    s_waitcnt vmcnt(10)
    v_mfma_f32_16x16x32_bf16 v[20:23], v[16:19], v[40:43], v[20:23]
    v_mfma_f32_16x16x32_bf16 v[24:27], v[16:19], v[44:47], v[24:27]
    s_waitcnt vmcnt(8)
    v_mfma_f32_16x16x32_bf16 v[20:23], v[16:19], v[48:51], v[20:23]
    v_mfma_f32_16x16x32_bf16 v[24:27], v[16:19], v[52:55], v[24:27]
    s_waitcnt vmcnt(6)
    v_mfma_f32_16x16x32_bf16 v[20:23], v[16:19], v[56:59], v[20:23]
    v_mfma_f32_16x16x32_bf16 v[24:27], v[16:19], v[60:63], v[24:27]
    s_waitcnt vmcnt(4)
    v_mfma_f32_16x16x32_bf16 v[20:23], v[16:19], v[64:67], v[20:23]
    v_mfma_f32_16x16x32_bf16 v[24:27], v[16:19], v[68:71], v[24:27]
    s_waitcnt vmcnt(2)
    v_mfma_f32_16x16x32_bf16 v[20:23], v[16:19], v[72:75], v[20:23]
    v_mfma_f32_16x16x32_bf16 v[24:27], v[16:19], v[76:79], v[24:27]
    s_waitcnt vmcnt(0)
    v_mfma_f32_16x16x32_bf16 v[20:23], v[16:19], v[80:83], v[20:23]
    v_mfma_f32_16x16x32_bf16 v[24:27], v[16:19], v[84:87], v[24:27]
    s_nop 7
    ds_write_b128 v7, v[20:23]
    ds_write_b128 v7, v[24:27] offset:512
    s_waitcnt lgkmcnt(0)
    s_barrier
    ds_read_b128 v[40:43], v14 offset:0
    ds_read_b128 v[44:47], v14 offset:1024
    ds_read_b128 v[48:51], v14 offset:2048
    ds_read_b128 v[52:55], v14 offset:3072
    ds_read_b128 v[56:59], v14 offset:4096
    ds_read_b128 v[60:63], v14 offset:5120
    ds_read_b128 v[64:67], v14 offset:6144
    ds_read_b128 v[68:71], v14 offset:7168
    v_lshrrev_b32 v7, 5, v2
    v_mul_u32_u24 v7, 6656, v7
    v_add_u32 v7, v7, v14
    s_lshl_b32 s62, s72, 9
    s_waitcnt lgkmcnt(0)
    s_barrier
    s_cmp_lg_u32 s88, 0
    s_cbranch_scc1 L_done_34
    v_pk_add_f32 v[40:41], v[40:41], v[44:45]
    v_pk_add_f32 v[42:43], v[42:43], v[46:47]
    v_pk_add_f32 v[40:41], v[40:41], v[48:49]
    v_pk_add_f32 v[42:43], v[42:43], v[50:51]
    v_pk_add_f32 v[40:41], v[40:41], v[52:53]
    v_pk_add_f32 v[42:43], v[42:43], v[54:55]
    v_pk_add_f32 v[40:41], v[40:41], v[56:57]
    v_pk_add_f32 v[42:43], v[42:43], v[58:59]
    v_pk_add_f32 v[40:41], v[40:41], v[60:61]
    v_pk_add_f32 v[42:43], v[42:43], v[62:63]
    v_pk_add_f32 v[40:41], v[40:41], v[64:65]
    v_pk_add_f32 v[42:43], v[42:43], v[66:67]
    v_pk_add_f32 v[40:41], v[40:41], v[68:69]
    v_pk_add_f32 v[42:43], v[42:43], v[70:71]
    buffer_store_dwordx4 v[40:43], v7, s[48:51], s62 offen sc1
    s_waitcnt vmcnt(0)
    v_mov_b32 v251, s100
    s_mul_i32 s90, s72, 128
    s_mov_b64 exec, 1
    buffer_store_dword v251, off, s[84:87], s90 offset:36 sc1
    s_mov_b64 exec, -1
L_done_34:
    s_sub_u32 s30, s30, 65536
    s_add_u32 m0, s31, 32768
    s_nop 0
    buffer_load_dwordx4 v248, s[52:55], s30 offen lds
    buffer_load_dwordx4 v249, s[52:55], s30 offen offset:1024 lds
    s_add_u32 s30, s30, 32768
    s_add_u32 m0, s31, 40960
    s_nop 0
    buffer_load_dwordx4 v248, s[52:55], s30 offen lds
    buffer_load_dwordx4 v249, s[52:55], s30 offen offset:1024 lds
    s_add_u32 s30, s30, 32768
    s_add_u32 m0, s3, 32768
    s_nop 0
    buffer_load_dwordx4 v248, s[52:55], s30 offen lds
    buffer_load_dwordx4 v249, s[52:55], s30 offen offset:1024 lds
    s_add_u32 s30, s30, 32768
    s_add_u32 m0, s31, 0
    s_nop 0
    buffer_load_dwordx4 v248, s[52:55], s30 offen lds
    buffer_load_dwordx4 v249, s[52:55], s30 offen offset:1024 lds
    s_add_u32 s30, s30, 32768
    v_lshrrev_b32 v3, 2, v2
    v_bfe_u32 v12, v2, 3, 2
    s_and_b32 s76, s88, 2
    v_xor_b32 v12, s76, v12
    v_lshlrev_b32 v12, 5, v12
    v_lshl_add_u32 v12, v3, 7, v12
    v_and_b32 v3, 3, v2
    v_lshl_add_u32 v12, v3, 3, v12
    s_and_b32 s76, s31, 0xfffff000
    v_add_u32 v4, s76, v12
    s_and_b32 s76, s3, 0xfffff000
    v_add_u32 v8, s76, v12
    v_xor_b32 v5, 32, v4
    v_xor_b32 v9, 32, v8
    v_xor_b32 v6, 64, v4
    v_xor_b32 v10, 64, v8
    v_xor_b32 v7, 96, v4
    v_xor_b32 v11, 96, v8
    s_waitcnt vmcnt(0)
    s_barrier
    ds_read_b64_tr_b16 v[216:217], v4 offset:32768
    ds_read_b64_tr_b16 v[218:219], v4 offset:34816
    ds_read_b64_tr_b16 v[220:221], v5 offset:32768
    ds_read_b64_tr_b16 v[222:223], v5 offset:34816
    ds_read_b64_tr_b16 v[224:225], v6 offset:32768
    ds_read_b64_tr_b16 v[226:227], v6 offset:34816
    ds_read_b64_tr_b16 v[228:229], v7 offset:32768
    ds_read_b64_tr_b16 v[230:231], v7 offset:34816
    ds_read_b64_tr_b16 v[232:233], v4 offset:40960
    ds_read_b64_tr_b16 v[234:235], v4 offset:43008
    ds_read_b64_tr_b16 v[236:237], v5 offset:40960
    ds_read_b64_tr_b16 v[238:239], v5 offset:43008
    ds_read_b64_tr_b16 v[240:241], v6 offset:40960
    ds_read_b64_tr_b16 v[242:243], v6 offset:43008
    ds_read_b64_tr_b16 v[244:245], v7 offset:40960
    ds_read_b64_tr_b16 v[246:247], v7 offset:43008
    ds_read_b64_tr_b16 v[200:201], v8 offset:32768
    ds_read_b64_tr_b16 v[202:203], v8 offset:34816
    ds_read_b64_tr_b16 v[204:205], v9 offset:32768
    ds_read_b64_tr_b16 v[206:207], v9 offset:34816
    ds_read_b64_tr_b16 v[208:209], v10 offset:32768
    ds_read_b64_tr_b16 v[210:211], v10 offset:34816
    ds_read_b64_tr_b16 v[212:213], v11 offset:32768
    ds_read_b64_tr_b16 v[214:215], v11 offset:34816
    ds_read_b64_tr_b16 v[56:57], v4 offset:0
    ds_read_b64_tr_b16 v[58:59], v4 offset:2048
    ds_read_b64_tr_b16 v[60:61], v5 offset:0
    ds_read_b64_tr_b16 v[62:63], v5 offset:2048
    ds_read_b64_tr_b16 v[64:65], v6 offset:0
    ds_read_b64_tr_b16 v[66:67], v6 offset:2048
    ds_read_b64_tr_b16 v[68:69], v7 offset:0
    ds_read_b64_tr_b16 v[70:71], v7 offset:2048
    s_waitcnt lgkmcnt(0)
    s_barrier
    s_add_u32 m0, s31, 32768
    s_nop 0
    buffer_load_dwordx4 v248, s[52:55], s30 offen lds
    buffer_load_dwordx4 v249, s[52:55], s30 offen offset:1024 lds
    s_add_u32 s30, s30, 32768
    s_add_u32 m0, s31, 40960
    s_nop 0
    buffer_load_dwordx4 v248, s[52:55], s30 offen lds
    buffer_load_dwordx4 v249, s[52:55], s30 offen offset:1024 lds
    s_add_u32 s30, s30, 32768
    s_add_u32 m0, s3, 32768
    s_nop 0
    buffer_load_dwordx4 v248, s[52:55], s30 offen lds
    buffer_load_dwordx4 v249, s[52:55], s30 offen offset:1024 lds
    s_add_u32 s30, s30, 32768
    s_add_u32 m0, s31, 0
    s_nop 0
    buffer_load_dwordx4 v248, s[52:55], s30 offen lds
    buffer_load_dwordx4 v249, s[52:55], s30 offen offset:1024 lds
    s_add_u32 s30, s30, 32768
    s_add_u32 m0, s31, 8192
    s_nop 0
    buffer_load_dwordx4 v248, s[52:55], s30 offen lds
    buffer_load_dwordx4 v249, s[52:55], s30 offen offset:1024 lds
    s_add_u32 s30, s30, 32768
    s_add_u32 m0, s3, 0
    s_nop 0
    buffer_load_dwordx4 v248, s[52:55], s30 offen lds
    buffer_load_dwordx4 v249, s[52:55], s30 offen offset:1024 lds
    s_add_u32 s30, s30, 32768
    s_add_u32 m0, s31, 16384
    s_nop 0
    buffer_load_dwordx4 v248, s[52:55], s30 offen lds
    buffer_load_dwordx4 v249, s[52:55], s30 offen offset:1024 lds
    s_add_u32 s30, s30, 32768
    s_add_u32 m0, s31, 24576
    s_nop 0
    buffer_load_dwordx4 v248, s[52:55], s30 offen lds
    buffer_load_dwordx4 v249, s[52:55], s30 offen offset:1024 lds
    s_add_u32 s30, s30, 32768
    s_add_u32 m0, s3, 16384
    s_nop 0
    buffer_load_dwordx4 v248, s[52:55], s30 offen lds
    buffer_load_dwordx4 v249, s[52:55], s30 offen offset:1024 lds
    s_add_u32 s30, s30, 32768
    s_add_u32 m0, s3, 49152
    s_nop 0
    buffer_load_dwordx4 v248, s[52:55], s30 offen lds
    buffer_load_dwordx4 v249, s[52:55], s30 offen offset:1024 lds
    s_add_u32 s30, s30, 32768
    s_waitcnt vmcnt(0)
    s_branch L_p3
L_code_end:
.section .rodata,"a"
.p2align 6
.amdhsa_kernel sequential_preLN__ssm_conv_h3__geglu_ffn__prompt_kernel
  .amdhsa_next_free_vgpr 256
  .amdhsa_next_free_sgpr 102
  .amdhsa_accum_offset 256
  .amdhsa_group_segment_fixed_size 0
  .amdhsa_kernarg_size 104
  .amdhsa_user_sgpr_count 2
  .amdhsa_user_sgpr_kernarg_segment_ptr 1
  .amdhsa_system_sgpr_workgroup_id_x 1
.end_amdhsa_kernel
```
